```python
import torch

def _softmax(x, axis=-1):
    return torch.softmax(x, dim=axis)
def _gelu(x):
    return torch.nn.functional.gelu(x, approximate="tanh")
def _silu(x):
    return torch.nn.functional.silu(x)
def _sigmoid(x):
    return torch.sigmoid(x)
def _layernorm(x, axis=-1, eps=1e-5):
    m = x.mean(dim=axis, keepdim=True)
    v = x.var(dim=axis, keepdim=True, unbiased=False)
    return (x - m) / torch.sqrt(v + eps)
def _scatter_add(tgt, idx, src, axis=0):
    return tgt.clone().index_add_(axis, idx, src)
def _segment_sum(src, seg, n):
    out = torch.zeros((n,) + src.shape[1:], dtype=src.dtype)
    return out.index_add_(0, seg, src)
def _pad(x, pw):
    flat = tuple(v for pair in reversed(pw) for v in pair)
    return torch.nn.functional.pad(x, flat)

kernel_name = 'parallel_sum__grouped_kv_mqa__mixer_token_mlp__prompt'

def setup_inputs():

    _w = (lambda a: (lambda t: t.to(torch.bfloat16) if t.is_floating_point() else t)(torch.as_tensor(a)))
    def _A_setup():
        B, S, D, H = 1, 2048, 640, 32
        Dh = D // H
        return {
            "x": _w((lambda *s: torch.randn(*s, dtype=torch.bfloat16) * 0.05)(B, S, D)),
            "wq": _w((lambda *s: torch.randn(*s, dtype=torch.bfloat16) * 0.05)(D, H * Dh)),
            "wk": _w((lambda *s: torch.randn(*s, dtype=torch.bfloat16) * 0.05)(D, Dh)),
            "wv": _w((lambda *s: torch.randn(*s, dtype=torch.bfloat16) * 0.05)(D, Dh)),
            "wo": _w((lambda *s: torch.randn(*s, dtype=torch.bfloat16) * 0.05)(H * Dh, D)),
        }
    _A_in = _A_setup()

    def _B_setup():
        B, S, D, F = 1, 2048, 640, 1536
        return {
            "x": _w((lambda *s: torch.randn(*s, dtype=torch.bfloat16) * 0.05)(B, S, D)),
            "w1": _w((lambda *s: torch.randn(*s, dtype=torch.bfloat16) * 1.6)(S, F) * (S ** -0.5)),
            "b1": _w((lambda *s: torch.randn(*s, dtype=torch.bfloat16) * 12.8)(F) * 0.02),
            "w2": _w((lambda *s: torch.randn(*s, dtype=torch.bfloat16) * 0.8)(F, S) * (F ** -0.5)),
            "b2": _w((lambda *s: torch.randn(*s, dtype=torch.bfloat16) * 12.8)(S) * 0.02),
        }
    _B_in = _B_setup()

    return {
        "A_x": _A_in["x"],
        "A_wq": _A_in["wq"],
        "A_wk": _A_in["wk"],
        "A_wv": _A_in["wv"],
        "A_wo": _A_in["wo"],
        "B_x": _B_in["x"],
        "B_w1": _B_in["w1"],
        "B_b1": _B_in["b1"],
        "B_w2": _B_in["w2"],
        "B_b2": _B_in["b2"],
    }

def reference(A_x, A_wq, A_wk, A_wv, A_wo, B_x, B_w1, B_b1, B_w2, B_b2):
    def _A_ref(x, wq, wk, wv, wo):
        B, S, D = x.shape
        H = 32
        Dh = D // H
        q = (lambda x, *d: x.permute(*d))((x @ wq).reshape(B, S, H, Dh), 0, 2, 1, 3)
        k = x @ wk
        v = x @ wv
        scores = torch.einsum("bhqd,bkd->bhqk", q, k) * (Dh ** -0.5)
        p = _softmax(scores, axis=-1)
        o = torch.einsum("bhqk,bkd->bhqd", p, v)
        return (lambda x, *d: x.permute(*d))(o, 0, 2, 1, 3).reshape(B, S, H * Dh) @ wo

    def _B_ref(x, w1, b1, w2, b2):
        B, S, D = x.shape
        h = _layernorm(x, axis=-1)
        u = torch.einsum("bsd,sf->bdf", h, w1) + b1
        u = _gelu(u)
        y = torch.einsum("bdf,fs->bds", u, w2) + b2
        return (lambda x, *d: x.permute(*d))(y, 0, 2, 1)

    x = A_x
    xn = _layernorm(x, axis=-1)
    return x + _A_ref(xn, A_wq, A_wk, A_wv, A_wo) + _B_ref(xn, B_w1, B_b1, B_w2, B_b2)
```

```asm
; @launch grid=(256,1,1) block=(512,1,1) lds=162176
.amdgcn_target "amdgcn-amd-amdhsa--gfx950"
.text
.globl parallel_sum__grouped_kv_mqa__mixer_token_mlp__prompt_kernel
.p2align 8
.type parallel_sum__grouped_kv_mqa__mixer_token_mlp__prompt_kernel,@function
parallel_sum__grouped_kv_mqa__mixer_token_mlp__prompt_kernel:

    s_cmp_ge_u32 s2, 256
    s_cbranch_scc1 L_end
    s_load_dwordx2 s[14:15], s[0:1], 96
    s_load_dwordx8 s[20:27], s[0:1], 0
    s_load_dwordx2 s[28:29], s[0:1], 48
    v_lshrrev_b32 v1, 6, v0
    v_and_b32 v0, 63, v0
    v_readfirstlane_b32 s10, v1
    v_mov_b32 v1, 0
    v_lshlrev_b32 v2, 2, v0
    v_add_u32 v2, 161792, v2
    s_cmp_lg_u32 s10, 7
    s_cbranch_scc1 L_nz
    s_mov_b64 exec, 0xffff
    ds_write_b32 v2, v1
    s_mov_b64 exec, -1
L_nz:
    s_and_b32 s13, s2, 7
    s_lshr_b32 s12, s2, 3
    s_lshl_b32 s8, s13, 2
    s_lshr_b32 s9, s12, 3
    s_add_u32 s8, s8, s9
    s_and_b32 s9, s12, 7
    v_and_b32 v1, 15, v0
    v_lshrrev_b32 v2, 4, v0
    s_lshr_b32 s36, s9, 1
    s_cmp_lt_u32 s10, 4
    s_cselect_b32 s39, s10, s36
    s_lshl_b32 s37, s8, 2
    s_add_u32 s37, s37, s39
    s_mul_i32 s38, s37, 20480
    v_mul_u32_u24 v3, 1280, v1
    v_lshl_add_u32 v3, v2, 4, v3
    v_mov_b32 v8, 161792
    v_mov_b32 v9, 1
    s_and_b32 s44, s8, 3
    s_mul_i32 s44, s44, 5
    s_cmp_eq_u32 s10, 5
    s_cselect_b32 s44, 0, s44
    s_lshl_b32 s50, s44, 6
    s_add_u32 s50, s50, s38
    s_add_u32 s51, s44, 5
    s_cmp_ge_u32 s51, 20
    s_cselect_b32 s51, 1280, 0
    s_sub_u32 s51, s50, s51
    s_add_u32 s52, s44, 10
    s_cmp_ge_u32 s52, 20
    s_cselect_b32 s52, 1280, 0
    s_sub_u32 s52, s50, s52
    s_add_u32 s53, s44, 15
    s_cmp_ge_u32 s53, 20
    s_cselect_b32 s53, 1280, 0
    s_sub_u32 s53, s50, s53
    s_waitcnt lgkmcnt(0)
    s_barrier
    s_cmp_lt_u32 s10, 4
    s_cbranch_scc1 L_near_done
    s_cmp_eq_u32 s10, 5
    s_cbranch_scc1 L_near_done
    s_and_b32 s39, s9, 1
    s_cmp_eq_u32 s39, 1
    s_cselect_b32 s56, s26, s24
    s_cselect_b32 s57, s27, s25
    s_and_b32 s57, s57, 0xffff
    s_mov_b32 s58, 25600
    s_mov_b32 s59, 0x20000
    s_sub_u32 s60, s10, 5
    s_max_i32 s60, s60, 0
    s_lshl_b32 s60, s60, 10
    v_lshlrev_b32 v7, 4, v0
    s_mov_b32 s39, s60
    s_add_u32 m0, s60, 102400
    s_nop 0
    buffer_load_dwordx4 v7, s[56:59], s39 offen lds
    s_add_u32 m0, s60, 105472
    s_add_u32 s39, s39, 3072
    buffer_load_dwordx4 v7, s[56:59], s39 offen lds
    s_add_u32 m0, s60, 108544
    s_add_u32 s39, s39, 3072
    buffer_load_dwordx4 v7, s[56:59], s39 offen lds
    s_add_u32 m0, s60, 111616
    s_add_u32 s39, s39, 3072
    buffer_load_dwordx4 v7, s[56:59], s39 offen lds
    s_add_u32 m0, s60, 114688
    s_add_u32 s39, s39, 3072
    buffer_load_dwordx4 v7, s[56:59], s39 offen lds
    s_add_u32 m0, s60, 117760
    s_add_u32 s39, s39, 3072
    buffer_load_dwordx4 v7, s[56:59], s39 offen lds
    s_add_u32 m0, s60, 120832
    s_add_u32 s39, s39, 3072
    buffer_load_dwordx4 v7, s[56:59], s39 offen lds
    s_add_u32 m0, s60, 123904
    s_add_u32 s39, s39, 3072
    buffer_load_dwordx4 v7, s[56:59], s39 offen lds
    s_cmp_lg_u32 s60, 0
    s_cbranch_scc1 L_near_done
    s_add_u32 m0, s60, 126976
    s_add_u32 s39, s39, 3072
    buffer_load_dwordx4 v7, s[56:59], s39 offen lds
L_near_done:
    s_mov_b32 s32, s20
    s_and_b32 s33, s21, 0xffff
    s_mov_b32 s34, 0x280000
    s_mov_b32 s35, 0x20000
    s_cmp_ge_u32 s10, 4
    s_cbranch_scc1 L_other
    s_cmp_lg_u32 s10, s36
    s_cbranch_scc1 L_pre
    buffer_load_dwordx4 v[12:15], v3, s[32:35], s50 offen offset:0
    buffer_load_dwordx4 v[16:19], v3, s[32:35], s50 offen offset:64
    buffer_load_dwordx4 v[20:23], v3, s[32:35], s50 offen offset:128
    buffer_load_dwordx4 v[24:27], v3, s[32:35], s50 offen offset:192
    buffer_load_dwordx4 v[28:31], v3, s[32:35], s50 offen offset:256
    buffer_load_dwordx4 v[32:35], v3, s[32:35], s51 offen offset:320
    buffer_load_dwordx4 v[36:39], v3, s[32:35], s51 offen offset:384
    buffer_load_dwordx4 v[40:43], v3, s[32:35], s51 offen offset:448
    buffer_load_dwordx4 v[44:47], v3, s[32:35], s51 offen offset:512
    buffer_load_dwordx4 v[48:51], v3, s[32:35], s51 offen offset:576
    buffer_load_dwordx4 v[52:55], v3, s[32:35], s52 offen offset:640
    buffer_load_dwordx4 v[56:59], v3, s[32:35], s52 offen offset:704
    buffer_load_dwordx4 v[60:63], v3, s[32:35], s52 offen offset:768
    buffer_load_dwordx4 v[64:67], v3, s[32:35], s52 offen offset:832
    buffer_load_dwordx4 v[68:71], v3, s[32:35], s52 offen offset:896
    buffer_load_dwordx4 v[72:75], v3, s[32:35], s53 offen offset:960
    buffer_load_dwordx4 v[76:79], v3, s[32:35], s53 offen offset:1024
    buffer_load_dwordx4 v[80:83], v3, s[32:35], s53 offen offset:1088
    buffer_load_dwordx4 v[84:87], v3, s[32:35], s53 offen offset:1152
    buffer_load_dwordx4 v[88:91], v3, s[32:35], s53 offen offset:1216
L_pre:
    s_mov_b32 s4, s14
    s_and_b32 s5, s15, 0xffff
    s_mov_b32 s6, 0x10000000
    s_mov_b32 s7, 0x20000
    s_load_dword s11, s[14:15], 0
L_nonce_done:
    v_lshlrev_b32 v7, 4, v0
    v_bfe_u32 v4, v0, 2, 2
    v_and_b32 v5, 3, v0
    v_lshl_add_u32 v6, v2, 2, v4
    v_mul_u32_u24 v110, 160, v6
    v_lshl_add_u32 v110, v5, 3, v110
    v_add_u32 v111, 51200, v110
    v_lshl_add_u32 v6, v2, 3, v4
    v_mul_u32_u24 v180, 40, v6
    v_lshl_add_u32 v180, v5, 3, v180
    v_add_u32 v180, 102400, v180
    s_and_b32 s40, s10, 1
    s_lshl_b32 s40, s40, 4
    v_add_u32 v181, s40, v1
    s_lshr_b32 s42, s37, 1
    s_mul_i32 s42, s42, 2688
    s_add_u32 s42, s42, 65536
    s_lshr_b32 s40, s10, 1
    s_mul_i32 s40, s40, 1280
    s_add_u32 s40, s40, 151552
    v_add_u32 v4, 0, v2
    v_mul_u32_u24 v5, 52, v4
    v_lshrrev_b32 v5, 8, v5
    v_mul_u32_u24 v6, 5, v5
    v_sub_u32 v4, v4, v6
    v_mul_u32_u24 v112, 2560, v5
    v_lshrrev_b32 v5, 1, v4
    v_lshlrev_b32 v5, 9, v5
    v_lshl_add_u32 v5, v181, 4, v5
    v_and_b32 v6, 1, v4
    v_lshl_add_u32 v5, v6, 3, v5
    v_lshlrev_b32 v6, 3, v181
    v_add_u32 v6, 1024, v6
    v_cmp_eq_u32 vcc, 4, v4
    v_add_u32 v112, s40, v112
    s_nop 0
    v_cndmask_b32 v5, v5, v6, vcc
    v_add_u32 v112, v112, v5
    v_add_u32 v4, 4, v2
    v_mul_u32_u24 v5, 52, v4
    v_lshrrev_b32 v5, 8, v5
    v_mul_u32_u24 v6, 5, v5
    v_sub_u32 v4, v4, v6
    v_mul_u32_u24 v113, 2560, v5
    v_lshrrev_b32 v5, 1, v4
    v_lshlrev_b32 v5, 9, v5
    v_lshl_add_u32 v5, v181, 4, v5
    v_and_b32 v6, 1, v4
    v_lshl_add_u32 v5, v6, 3, v5
    v_lshlrev_b32 v6, 3, v181
    v_add_u32 v6, 1024, v6
    v_cmp_eq_u32 vcc, 4, v4
    v_add_u32 v113, s40, v113
    s_nop 0
    v_cndmask_b32 v5, v5, v6, vcc
    v_add_u32 v113, v113, v5
    v_add_u32 v4, 8, v2
    v_mul_u32_u24 v5, 52, v4
    v_lshrrev_b32 v5, 8, v5
    v_mul_u32_u24 v6, 5, v5
    v_sub_u32 v4, v4, v6
    v_mul_u32_u24 v114, 2560, v5
    v_lshrrev_b32 v5, 1, v4
    v_lshlrev_b32 v5, 9, v5
    v_lshl_add_u32 v5, v181, 4, v5
    v_and_b32 v6, 1, v4
    v_lshl_add_u32 v5, v6, 3, v5
    v_lshlrev_b32 v6, 3, v181
    v_add_u32 v6, 1024, v6
    v_cmp_eq_u32 vcc, 4, v4
    v_add_u32 v114, s40, v114
    s_nop 0
    v_cndmask_b32 v5, v5, v6, vcc
    v_add_u32 v114, v114, v5
    v_add_u32 v4, 12, v2
    v_mul_u32_u24 v5, 52, v4
    v_lshrrev_b32 v5, 8, v5
    v_mul_u32_u24 v6, 5, v5
    v_sub_u32 v4, v4, v6
    v_mul_u32_u24 v115, 2560, v5
    v_lshrrev_b32 v5, 1, v4
    v_lshlrev_b32 v5, 9, v5
    v_lshl_add_u32 v5, v181, 4, v5
    v_and_b32 v6, 1, v4
    v_lshl_add_u32 v5, v6, 3, v5
    v_lshlrev_b32 v6, 3, v181
    v_add_u32 v6, 1024, v6
    v_cmp_eq_u32 vcc, 4, v4
    v_add_u32 v115, s40, v115
    s_nop 0
    v_cndmask_b32 v5, v5, v6, vcc
    v_add_u32 v115, v115, v5
    v_add_u32 v4, 16, v2
    v_mul_u32_u24 v5, 52, v4
    v_lshrrev_b32 v5, 8, v5
    v_mul_u32_u24 v6, 5, v5
    v_sub_u32 v4, v4, v6
    v_mul_u32_u24 v116, 2560, v5
    v_lshrrev_b32 v5, 1, v4
    v_lshlrev_b32 v5, 9, v5
    v_lshl_add_u32 v5, v181, 4, v5
    v_and_b32 v6, 1, v4
    v_lshl_add_u32 v5, v6, 3, v5
    v_lshlrev_b32 v6, 3, v181
    v_add_u32 v6, 1024, v6
    v_cmp_eq_u32 vcc, 4, v4
    v_add_u32 v116, s40, v116
    s_nop 0
    v_cndmask_b32 v5, v5, v6, vcc
    v_add_u32 v116, v116, v5
    s_cmp_eq_u32 s10, s36
    s_cbranch_scc1 L_stats0
L_xload:
    buffer_load_dwordx4 v[12:15], v3, s[32:35], s50 offen offset:0
    buffer_load_dwordx4 v[16:19], v3, s[32:35], s50 offen offset:64
    buffer_load_dwordx4 v[20:23], v3, s[32:35], s50 offen offset:128
    buffer_load_dwordx4 v[24:27], v3, s[32:35], s50 offen offset:192
    buffer_load_dwordx4 v[28:31], v3, s[32:35], s50 offen offset:256
    buffer_load_dwordx4 v[32:35], v3, s[32:35], s51 offen offset:320
    buffer_load_dwordx4 v[36:39], v3, s[32:35], s51 offen offset:384
    buffer_load_dwordx4 v[40:43], v3, s[32:35], s51 offen offset:448
    buffer_load_dwordx4 v[44:47], v3, s[32:35], s51 offen offset:512
    buffer_load_dwordx4 v[48:51], v3, s[32:35], s51 offen offset:576
    buffer_load_dwordx4 v[52:55], v3, s[32:35], s52 offen offset:640
    buffer_load_dwordx4 v[56:59], v3, s[32:35], s52 offen offset:704
    buffer_load_dwordx4 v[60:63], v3, s[32:35], s52 offen offset:768
    buffer_load_dwordx4 v[64:67], v3, s[32:35], s52 offen offset:832
    buffer_load_dwordx4 v[68:71], v3, s[32:35], s52 offen offset:896
    buffer_load_dwordx4 v[72:75], v3, s[32:35], s53 offen offset:960
    buffer_load_dwordx4 v[76:79], v3, s[32:35], s53 offen offset:1024
    buffer_load_dwordx4 v[80:83], v3, s[32:35], s53 offen offset:1088
    buffer_load_dwordx4 v[84:87], v3, s[32:35], s53 offen offset:1152
    buffer_load_dwordx4 v[88:91], v3, s[32:35], s53 offen offset:1216
    v_lshlrev_b32 v7, 4, v0
L_stats0:
L_stats:
    s_mov_b32 s48, 0x3f803f80
    s_mov_b32 s49, 0xffff0000
    v_mov_b32 v92, 0
    v_mov_b32 v93, 0
    v_mov_b32 v94, 0
    v_mov_b32 v95, 0
    s_waitcnt vmcnt(19)
    v_dot2c_f32_bf16 v92, 0x3f803f80, v12
    v_dot2c_f32_bf16 v94, v12, v12
    v_dot2c_f32_bf16 v93, 0x3f803f80, v13
    v_dot2c_f32_bf16 v95, v13, v13
    v_dot2c_f32_bf16 v92, 0x3f803f80, v14
    v_dot2c_f32_bf16 v94, v14, v14
    v_dot2c_f32_bf16 v93, 0x3f803f80, v15
    v_dot2c_f32_bf16 v95, v15, v15
    s_waitcnt vmcnt(18)
    v_dot2c_f32_bf16 v92, 0x3f803f80, v16
    v_dot2c_f32_bf16 v94, v16, v16
    v_dot2c_f32_bf16 v93, 0x3f803f80, v17
    v_dot2c_f32_bf16 v95, v17, v17
    v_dot2c_f32_bf16 v92, 0x3f803f80, v18
    v_dot2c_f32_bf16 v94, v18, v18
    v_dot2c_f32_bf16 v93, 0x3f803f80, v19
    v_dot2c_f32_bf16 v95, v19, v19
    s_waitcnt vmcnt(17)
    v_dot2c_f32_bf16 v92, 0x3f803f80, v20
    v_dot2c_f32_bf16 v94, v20, v20
    v_dot2c_f32_bf16 v93, 0x3f803f80, v21
    v_dot2c_f32_bf16 v95, v21, v21
    v_dot2c_f32_bf16 v92, 0x3f803f80, v22
    v_dot2c_f32_bf16 v94, v22, v22
    v_dot2c_f32_bf16 v93, 0x3f803f80, v23
    v_dot2c_f32_bf16 v95, v23, v23
    s_waitcnt vmcnt(16)
    v_dot2c_f32_bf16 v92, 0x3f803f80, v24
    v_dot2c_f32_bf16 v94, v24, v24
    v_dot2c_f32_bf16 v93, 0x3f803f80, v25
    v_dot2c_f32_bf16 v95, v25, v25
    v_dot2c_f32_bf16 v92, 0x3f803f80, v26
    v_dot2c_f32_bf16 v94, v26, v26
    v_dot2c_f32_bf16 v93, 0x3f803f80, v27
    v_dot2c_f32_bf16 v95, v27, v27
    s_waitcnt vmcnt(15)
    v_dot2c_f32_bf16 v92, 0x3f803f80, v28
    v_dot2c_f32_bf16 v94, v28, v28
    v_dot2c_f32_bf16 v93, 0x3f803f80, v29
    v_dot2c_f32_bf16 v95, v29, v29
    v_dot2c_f32_bf16 v92, 0x3f803f80, v30
    v_dot2c_f32_bf16 v94, v30, v30
    v_dot2c_f32_bf16 v93, 0x3f803f80, v31
    v_dot2c_f32_bf16 v95, v31, v31
    s_waitcnt vmcnt(14)
    v_dot2c_f32_bf16 v92, 0x3f803f80, v32
    v_dot2c_f32_bf16 v94, v32, v32
    v_dot2c_f32_bf16 v93, 0x3f803f80, v33
    v_dot2c_f32_bf16 v95, v33, v33
    v_dot2c_f32_bf16 v92, 0x3f803f80, v34
    v_dot2c_f32_bf16 v94, v34, v34
    v_dot2c_f32_bf16 v93, 0x3f803f80, v35
    v_dot2c_f32_bf16 v95, v35, v35
    s_waitcnt vmcnt(13)
    v_dot2c_f32_bf16 v92, 0x3f803f80, v36
    v_dot2c_f32_bf16 v94, v36, v36
    v_dot2c_f32_bf16 v93, 0x3f803f80, v37
    v_dot2c_f32_bf16 v95, v37, v37
    v_dot2c_f32_bf16 v92, 0x3f803f80, v38
    v_dot2c_f32_bf16 v94, v38, v38
    v_dot2c_f32_bf16 v93, 0x3f803f80, v39
    v_dot2c_f32_bf16 v95, v39, v39
    s_waitcnt vmcnt(12)
    v_dot2c_f32_bf16 v92, 0x3f803f80, v40
    v_dot2c_f32_bf16 v94, v40, v40
    v_dot2c_f32_bf16 v93, 0x3f803f80, v41
    v_dot2c_f32_bf16 v95, v41, v41
    v_dot2c_f32_bf16 v92, 0x3f803f80, v42
    v_dot2c_f32_bf16 v94, v42, v42
    v_dot2c_f32_bf16 v93, 0x3f803f80, v43
    v_dot2c_f32_bf16 v95, v43, v43
    s_waitcnt vmcnt(11)
    v_dot2c_f32_bf16 v92, 0x3f803f80, v44
    v_dot2c_f32_bf16 v94, v44, v44
    v_dot2c_f32_bf16 v93, 0x3f803f80, v45
    v_dot2c_f32_bf16 v95, v45, v45
    v_dot2c_f32_bf16 v92, 0x3f803f80, v46
    v_dot2c_f32_bf16 v94, v46, v46
    v_dot2c_f32_bf16 v93, 0x3f803f80, v47
    v_dot2c_f32_bf16 v95, v47, v47
    s_waitcnt vmcnt(10)
    v_dot2c_f32_bf16 v92, 0x3f803f80, v48
    v_dot2c_f32_bf16 v94, v48, v48
    v_dot2c_f32_bf16 v93, 0x3f803f80, v49
    v_dot2c_f32_bf16 v95, v49, v49
    v_dot2c_f32_bf16 v92, 0x3f803f80, v50
    v_dot2c_f32_bf16 v94, v50, v50
    v_dot2c_f32_bf16 v93, 0x3f803f80, v51
    v_dot2c_f32_bf16 v95, v51, v51
    s_waitcnt vmcnt(9)
    v_dot2c_f32_bf16 v92, 0x3f803f80, v52
    v_dot2c_f32_bf16 v94, v52, v52
    v_dot2c_f32_bf16 v93, 0x3f803f80, v53
    v_dot2c_f32_bf16 v95, v53, v53
    v_dot2c_f32_bf16 v92, 0x3f803f80, v54
    v_dot2c_f32_bf16 v94, v54, v54
    v_dot2c_f32_bf16 v93, 0x3f803f80, v55
    v_dot2c_f32_bf16 v95, v55, v55
    s_waitcnt vmcnt(8)
    v_dot2c_f32_bf16 v92, 0x3f803f80, v56
    v_dot2c_f32_bf16 v94, v56, v56
    v_dot2c_f32_bf16 v93, 0x3f803f80, v57
    v_dot2c_f32_bf16 v95, v57, v57
    v_dot2c_f32_bf16 v92, 0x3f803f80, v58
    v_dot2c_f32_bf16 v94, v58, v58
    v_dot2c_f32_bf16 v93, 0x3f803f80, v59
    v_dot2c_f32_bf16 v95, v59, v59
    s_waitcnt vmcnt(7)
    v_dot2c_f32_bf16 v92, 0x3f803f80, v60
    v_dot2c_f32_bf16 v94, v60, v60
    v_dot2c_f32_bf16 v93, 0x3f803f80, v61
    v_dot2c_f32_bf16 v95, v61, v61
    v_dot2c_f32_bf16 v92, 0x3f803f80, v62
    v_dot2c_f32_bf16 v94, v62, v62
    v_dot2c_f32_bf16 v93, 0x3f803f80, v63
    v_dot2c_f32_bf16 v95, v63, v63
    s_waitcnt vmcnt(6)
    v_dot2c_f32_bf16 v92, 0x3f803f80, v64
    v_dot2c_f32_bf16 v94, v64, v64
    v_dot2c_f32_bf16 v93, 0x3f803f80, v65
    v_dot2c_f32_bf16 v95, v65, v65
    v_dot2c_f32_bf16 v92, 0x3f803f80, v66
    v_dot2c_f32_bf16 v94, v66, v66
    v_dot2c_f32_bf16 v93, 0x3f803f80, v67
    v_dot2c_f32_bf16 v95, v67, v67
    s_waitcnt vmcnt(5)
    v_dot2c_f32_bf16 v92, 0x3f803f80, v68
    v_dot2c_f32_bf16 v94, v68, v68
    v_dot2c_f32_bf16 v93, 0x3f803f80, v69
    v_dot2c_f32_bf16 v95, v69, v69
    v_dot2c_f32_bf16 v92, 0x3f803f80, v70
    v_dot2c_f32_bf16 v94, v70, v70
    v_dot2c_f32_bf16 v93, 0x3f803f80, v71
    v_dot2c_f32_bf16 v95, v71, v71
    s_waitcnt vmcnt(4)
    v_dot2c_f32_bf16 v92, 0x3f803f80, v72
    v_dot2c_f32_bf16 v94, v72, v72
    v_dot2c_f32_bf16 v93, 0x3f803f80, v73
    v_dot2c_f32_bf16 v95, v73, v73
    v_dot2c_f32_bf16 v92, 0x3f803f80, v74
    v_dot2c_f32_bf16 v94, v74, v74
    v_dot2c_f32_bf16 v93, 0x3f803f80, v75
    v_dot2c_f32_bf16 v95, v75, v75
    s_waitcnt vmcnt(3)
    v_dot2c_f32_bf16 v92, 0x3f803f80, v76
    v_dot2c_f32_bf16 v94, v76, v76
    v_dot2c_f32_bf16 v93, 0x3f803f80, v77
    v_dot2c_f32_bf16 v95, v77, v77
    v_dot2c_f32_bf16 v92, 0x3f803f80, v78
    v_dot2c_f32_bf16 v94, v78, v78
    v_dot2c_f32_bf16 v93, 0x3f803f80, v79
    v_dot2c_f32_bf16 v95, v79, v79
    s_waitcnt vmcnt(2)
    v_dot2c_f32_bf16 v92, 0x3f803f80, v80
    v_dot2c_f32_bf16 v94, v80, v80
    v_dot2c_f32_bf16 v93, 0x3f803f80, v81
    v_dot2c_f32_bf16 v95, v81, v81
    v_dot2c_f32_bf16 v92, 0x3f803f80, v82
    v_dot2c_f32_bf16 v94, v82, v82
    v_dot2c_f32_bf16 v93, 0x3f803f80, v83
    v_dot2c_f32_bf16 v95, v83, v83
    s_waitcnt vmcnt(1)
    v_dot2c_f32_bf16 v92, 0x3f803f80, v84
    v_dot2c_f32_bf16 v94, v84, v84
    v_dot2c_f32_bf16 v93, 0x3f803f80, v85
    v_dot2c_f32_bf16 v95, v85, v85
    v_dot2c_f32_bf16 v92, 0x3f803f80, v86
    v_dot2c_f32_bf16 v94, v86, v86
    v_dot2c_f32_bf16 v93, 0x3f803f80, v87
    v_dot2c_f32_bf16 v95, v87, v87
    s_waitcnt vmcnt(0)
    v_dot2c_f32_bf16 v92, 0x3f803f80, v88
    v_dot2c_f32_bf16 v94, v88, v88
    v_dot2c_f32_bf16 v93, 0x3f803f80, v89
    v_dot2c_f32_bf16 v95, v89, v89
    v_dot2c_f32_bf16 v92, 0x3f803f80, v90
    v_dot2c_f32_bf16 v94, v90, v90
    v_dot2c_f32_bf16 v93, 0x3f803f80, v91
    v_dot2c_f32_bf16 v95, v91, v91
    s_cmp_eq_u32 s10, 5
    s_cbranch_scc1 L_nosig
    s_mov_b64 exec, 1
    ds_add_u32 v8, v9 offset:40
    s_mov_b64 exec, -1
L_nosig:
    s_nop 0
    v_add_f32 v92, v92, v93
    v_add_f32 v94, v94, v95
    v_mov_b32 v4, v92
    s_nop 1
    v_permlane16_swap_b32 v92, v4
    s_nop 0
    v_add_f32 v92, v92, v4
    v_mov_b32 v4, v92
    s_nop 1
    v_permlane32_swap_b32 v92, v4
    s_nop 0
    v_add_f32 v92, v92, v4
    v_mov_b32 v4, v94
    s_nop 1
    v_permlane16_swap_b32 v94, v4
    s_nop 0
    v_add_f32 v94, v94, v4
    v_mov_b32 v4, v94
    s_nop 1
    v_permlane32_swap_b32 v94, v4
    s_nop 0
    v_add_f32 v94, v94, v4
    v_mul_f32 v92, 0x3acccccd, v92
    v_mul_f32 v94, 0x3acccccd, v94
    v_fma_f32 v94, -v92, v92, v94
    v_max_f32 v94, 0, v94
    v_add_f32 v4, 0x3727c5ac, v94
    v_rsq_f32 v96, v4
    s_nop 0
    v_mul_f32 v98, v92, v96
    v_sub_f32 v98, 0, v98
    s_cmp_eq_u32 s10, 5
    s_cbranch_scc1 L_h
    v_lshlrev_b32 v102, 16, v12
    v_and_b32 v103, 0xffff0000, v12
    v_lshlrev_b32 v104, 16, v13
    v_and_b32 v105, 0xffff0000, v13
    v_lshlrev_b32 v106, 16, v14
    v_and_b32 v107, 0xffff0000, v14
    v_lshlrev_b32 v108, 16, v15
    v_and_b32 v109, 0xffff0000, v15
    v_pk_fma_f32 v[102:103], v[102:103], v[96:97], v[98:99] op_sel_hi:[1,0,0]
    v_pk_fma_f32 v[104:105], v[104:105], v[96:97], v[98:99] op_sel_hi:[1,0,0]
    v_pk_fma_f32 v[106:107], v[106:107], v[96:97], v[98:99] op_sel_hi:[1,0,0]
    v_pk_fma_f32 v[108:109], v[108:109], v[96:97], v[98:99] op_sel_hi:[1,0,0]
    v_cvt_pk_bf16_f32 v12, v102, v103
    v_cvt_pk_bf16_f32 v13, v104, v105
    v_cvt_pk_bf16_f32 v14, v106, v107
    v_cvt_pk_bf16_f32 v15, v108, v109
    v_lshlrev_b32 v102, 16, v16
    v_and_b32 v103, 0xffff0000, v16
    v_lshlrev_b32 v104, 16, v17
    v_and_b32 v105, 0xffff0000, v17
    v_lshlrev_b32 v106, 16, v18
    v_and_b32 v107, 0xffff0000, v18
    v_lshlrev_b32 v108, 16, v19
    v_and_b32 v109, 0xffff0000, v19
    v_pk_fma_f32 v[102:103], v[102:103], v[96:97], v[98:99] op_sel_hi:[1,0,0]
    v_pk_fma_f32 v[104:105], v[104:105], v[96:97], v[98:99] op_sel_hi:[1,0,0]
    v_pk_fma_f32 v[106:107], v[106:107], v[96:97], v[98:99] op_sel_hi:[1,0,0]
    v_pk_fma_f32 v[108:109], v[108:109], v[96:97], v[98:99] op_sel_hi:[1,0,0]
    v_cvt_pk_bf16_f32 v16, v102, v103
    v_cvt_pk_bf16_f32 v17, v104, v105
    v_cvt_pk_bf16_f32 v18, v106, v107
    v_cvt_pk_bf16_f32 v19, v108, v109
    v_lshlrev_b32 v102, 16, v20
    v_and_b32 v103, 0xffff0000, v20
    v_lshlrev_b32 v104, 16, v21
    v_and_b32 v105, 0xffff0000, v21
    v_lshlrev_b32 v106, 16, v22
    v_and_b32 v107, 0xffff0000, v22
    v_lshlrev_b32 v108, 16, v23
    v_and_b32 v109, 0xffff0000, v23
    v_pk_fma_f32 v[102:103], v[102:103], v[96:97], v[98:99] op_sel_hi:[1,0,0]
    v_pk_fma_f32 v[104:105], v[104:105], v[96:97], v[98:99] op_sel_hi:[1,0,0]
    v_pk_fma_f32 v[106:107], v[106:107], v[96:97], v[98:99] op_sel_hi:[1,0,0]
    v_pk_fma_f32 v[108:109], v[108:109], v[96:97], v[98:99] op_sel_hi:[1,0,0]
    v_cvt_pk_bf16_f32 v20, v102, v103
    v_cvt_pk_bf16_f32 v21, v104, v105
    v_cvt_pk_bf16_f32 v22, v106, v107
    v_cvt_pk_bf16_f32 v23, v108, v109
    v_lshlrev_b32 v102, 16, v24
    v_and_b32 v103, 0xffff0000, v24
    v_lshlrev_b32 v104, 16, v25
    v_and_b32 v105, 0xffff0000, v25
    v_lshlrev_b32 v106, 16, v26
    v_and_b32 v107, 0xffff0000, v26
    v_lshlrev_b32 v108, 16, v27
    v_and_b32 v109, 0xffff0000, v27
    v_pk_fma_f32 v[102:103], v[102:103], v[96:97], v[98:99] op_sel_hi:[1,0,0]
    v_pk_fma_f32 v[104:105], v[104:105], v[96:97], v[98:99] op_sel_hi:[1,0,0]
    v_pk_fma_f32 v[106:107], v[106:107], v[96:97], v[98:99] op_sel_hi:[1,0,0]
    v_pk_fma_f32 v[108:109], v[108:109], v[96:97], v[98:99] op_sel_hi:[1,0,0]
    v_cvt_pk_bf16_f32 v24, v102, v103
    v_cvt_pk_bf16_f32 v25, v104, v105
    v_cvt_pk_bf16_f32 v26, v106, v107
    v_cvt_pk_bf16_f32 v27, v108, v109
    v_lshlrev_b32 v102, 16, v28
    v_and_b32 v103, 0xffff0000, v28
    v_lshlrev_b32 v104, 16, v29
    v_and_b32 v105, 0xffff0000, v29
    v_lshlrev_b32 v106, 16, v30
    v_and_b32 v107, 0xffff0000, v30
    v_lshlrev_b32 v108, 16, v31
    v_and_b32 v109, 0xffff0000, v31
    v_pk_fma_f32 v[102:103], v[102:103], v[96:97], v[98:99] op_sel_hi:[1,0,0]
    v_pk_fma_f32 v[104:105], v[104:105], v[96:97], v[98:99] op_sel_hi:[1,0,0]
    v_pk_fma_f32 v[106:107], v[106:107], v[96:97], v[98:99] op_sel_hi:[1,0,0]
    v_pk_fma_f32 v[108:109], v[108:109], v[96:97], v[98:99] op_sel_hi:[1,0,0]
    v_cvt_pk_bf16_f32 v28, v102, v103
    v_cvt_pk_bf16_f32 v29, v104, v105
    v_cvt_pk_bf16_f32 v30, v106, v107
    v_cvt_pk_bf16_f32 v31, v108, v109
    v_lshlrev_b32 v102, 16, v32
    v_and_b32 v103, 0xffff0000, v32
    v_lshlrev_b32 v104, 16, v33
    v_and_b32 v105, 0xffff0000, v33
    v_lshlrev_b32 v106, 16, v34
    v_and_b32 v107, 0xffff0000, v34
    v_lshlrev_b32 v108, 16, v35
    v_and_b32 v109, 0xffff0000, v35
    v_pk_fma_f32 v[102:103], v[102:103], v[96:97], v[98:99] op_sel_hi:[1,0,0]
    v_pk_fma_f32 v[104:105], v[104:105], v[96:97], v[98:99] op_sel_hi:[1,0,0]
    v_pk_fma_f32 v[106:107], v[106:107], v[96:97], v[98:99] op_sel_hi:[1,0,0]
    v_pk_fma_f32 v[108:109], v[108:109], v[96:97], v[98:99] op_sel_hi:[1,0,0]
    v_cvt_pk_bf16_f32 v32, v102, v103
    v_cvt_pk_bf16_f32 v33, v104, v105
    v_cvt_pk_bf16_f32 v34, v106, v107
    v_cvt_pk_bf16_f32 v35, v108, v109
    v_lshlrev_b32 v102, 16, v36
    v_and_b32 v103, 0xffff0000, v36
    v_lshlrev_b32 v104, 16, v37
    v_and_b32 v105, 0xffff0000, v37
    v_lshlrev_b32 v106, 16, v38
    v_and_b32 v107, 0xffff0000, v38
    v_lshlrev_b32 v108, 16, v39
    v_and_b32 v109, 0xffff0000, v39
    v_pk_fma_f32 v[102:103], v[102:103], v[96:97], v[98:99] op_sel_hi:[1,0,0]
    v_pk_fma_f32 v[104:105], v[104:105], v[96:97], v[98:99] op_sel_hi:[1,0,0]
    v_pk_fma_f32 v[106:107], v[106:107], v[96:97], v[98:99] op_sel_hi:[1,0,0]
    v_pk_fma_f32 v[108:109], v[108:109], v[96:97], v[98:99] op_sel_hi:[1,0,0]
    v_cvt_pk_bf16_f32 v36, v102, v103
    v_cvt_pk_bf16_f32 v37, v104, v105
    v_cvt_pk_bf16_f32 v38, v106, v107
    v_cvt_pk_bf16_f32 v39, v108, v109
    v_lshlrev_b32 v102, 16, v40
    v_and_b32 v103, 0xffff0000, v40
    v_lshlrev_b32 v104, 16, v41
    v_and_b32 v105, 0xffff0000, v41
    v_lshlrev_b32 v106, 16, v42
    v_and_b32 v107, 0xffff0000, v42
    v_lshlrev_b32 v108, 16, v43
    v_and_b32 v109, 0xffff0000, v43
    v_pk_fma_f32 v[102:103], v[102:103], v[96:97], v[98:99] op_sel_hi:[1,0,0]
    v_pk_fma_f32 v[104:105], v[104:105], v[96:97], v[98:99] op_sel_hi:[1,0,0]
    v_pk_fma_f32 v[106:107], v[106:107], v[96:97], v[98:99] op_sel_hi:[1,0,0]
    v_pk_fma_f32 v[108:109], v[108:109], v[96:97], v[98:99] op_sel_hi:[1,0,0]
    v_cvt_pk_bf16_f32 v40, v102, v103
    v_cvt_pk_bf16_f32 v41, v104, v105
    v_cvt_pk_bf16_f32 v42, v106, v107
    v_cvt_pk_bf16_f32 v43, v108, v109
    v_lshlrev_b32 v102, 16, v44
    v_and_b32 v103, 0xffff0000, v44
    v_lshlrev_b32 v104, 16, v45
    v_and_b32 v105, 0xffff0000, v45
    v_lshlrev_b32 v106, 16, v46
    v_and_b32 v107, 0xffff0000, v46
    v_lshlrev_b32 v108, 16, v47
    v_and_b32 v109, 0xffff0000, v47
    v_pk_fma_f32 v[102:103], v[102:103], v[96:97], v[98:99] op_sel_hi:[1,0,0]
    v_pk_fma_f32 v[104:105], v[104:105], v[96:97], v[98:99] op_sel_hi:[1,0,0]
    v_pk_fma_f32 v[106:107], v[106:107], v[96:97], v[98:99] op_sel_hi:[1,0,0]
    v_pk_fma_f32 v[108:109], v[108:109], v[96:97], v[98:99] op_sel_hi:[1,0,0]
    v_cvt_pk_bf16_f32 v44, v102, v103
    v_cvt_pk_bf16_f32 v45, v104, v105
    v_cvt_pk_bf16_f32 v46, v106, v107
    v_cvt_pk_bf16_f32 v47, v108, v109
    v_lshlrev_b32 v102, 16, v48
    v_and_b32 v103, 0xffff0000, v48
    v_lshlrev_b32 v104, 16, v49
    v_and_b32 v105, 0xffff0000, v49
    v_lshlrev_b32 v106, 16, v50
    v_and_b32 v107, 0xffff0000, v50
    v_lshlrev_b32 v108, 16, v51
    v_and_b32 v109, 0xffff0000, v51
    v_pk_fma_f32 v[102:103], v[102:103], v[96:97], v[98:99] op_sel_hi:[1,0,0]
    v_pk_fma_f32 v[104:105], v[104:105], v[96:97], v[98:99] op_sel_hi:[1,0,0]
    v_pk_fma_f32 v[106:107], v[106:107], v[96:97], v[98:99] op_sel_hi:[1,0,0]
    v_pk_fma_f32 v[108:109], v[108:109], v[96:97], v[98:99] op_sel_hi:[1,0,0]
    v_cvt_pk_bf16_f32 v48, v102, v103
    v_cvt_pk_bf16_f32 v49, v104, v105
    v_cvt_pk_bf16_f32 v50, v106, v107
    v_cvt_pk_bf16_f32 v51, v108, v109
    v_lshlrev_b32 v102, 16, v52
    v_and_b32 v103, 0xffff0000, v52
    v_lshlrev_b32 v104, 16, v53
    v_and_b32 v105, 0xffff0000, v53
    v_lshlrev_b32 v106, 16, v54
    v_and_b32 v107, 0xffff0000, v54
    v_lshlrev_b32 v108, 16, v55
    v_and_b32 v109, 0xffff0000, v55
    v_pk_fma_f32 v[102:103], v[102:103], v[96:97], v[98:99] op_sel_hi:[1,0,0]
    v_pk_fma_f32 v[104:105], v[104:105], v[96:97], v[98:99] op_sel_hi:[1,0,0]
    v_pk_fma_f32 v[106:107], v[106:107], v[96:97], v[98:99] op_sel_hi:[1,0,0]
    v_pk_fma_f32 v[108:109], v[108:109], v[96:97], v[98:99] op_sel_hi:[1,0,0]
    v_cvt_pk_bf16_f32 v52, v102, v103
    v_cvt_pk_bf16_f32 v53, v104, v105
    v_cvt_pk_bf16_f32 v54, v106, v107
    v_cvt_pk_bf16_f32 v55, v108, v109
    v_lshlrev_b32 v102, 16, v56
    v_and_b32 v103, 0xffff0000, v56
    v_lshlrev_b32 v104, 16, v57
    v_and_b32 v105, 0xffff0000, v57
    v_lshlrev_b32 v106, 16, v58
    v_and_b32 v107, 0xffff0000, v58
    v_lshlrev_b32 v108, 16, v59
    v_and_b32 v109, 0xffff0000, v59
    v_pk_fma_f32 v[102:103], v[102:103], v[96:97], v[98:99] op_sel_hi:[1,0,0]
    v_pk_fma_f32 v[104:105], v[104:105], v[96:97], v[98:99] op_sel_hi:[1,0,0]
    v_pk_fma_f32 v[106:107], v[106:107], v[96:97], v[98:99] op_sel_hi:[1,0,0]
    v_pk_fma_f32 v[108:109], v[108:109], v[96:97], v[98:99] op_sel_hi:[1,0,0]
    v_cvt_pk_bf16_f32 v56, v102, v103
    v_cvt_pk_bf16_f32 v57, v104, v105
    v_cvt_pk_bf16_f32 v58, v106, v107
    v_cvt_pk_bf16_f32 v59, v108, v109
    v_lshlrev_b32 v102, 16, v60
    v_and_b32 v103, 0xffff0000, v60
    v_lshlrev_b32 v104, 16, v61
    v_and_b32 v105, 0xffff0000, v61
    v_lshlrev_b32 v106, 16, v62
    v_and_b32 v107, 0xffff0000, v62
    v_lshlrev_b32 v108, 16, v63
    v_and_b32 v109, 0xffff0000, v63
    v_pk_fma_f32 v[102:103], v[102:103], v[96:97], v[98:99] op_sel_hi:[1,0,0]
    v_pk_fma_f32 v[104:105], v[104:105], v[96:97], v[98:99] op_sel_hi:[1,0,0]
    v_pk_fma_f32 v[106:107], v[106:107], v[96:97], v[98:99] op_sel_hi:[1,0,0]
    v_pk_fma_f32 v[108:109], v[108:109], v[96:97], v[98:99] op_sel_hi:[1,0,0]
    v_cvt_pk_bf16_f32 v60, v102, v103
    v_cvt_pk_bf16_f32 v61, v104, v105
    v_cvt_pk_bf16_f32 v62, v106, v107
    v_cvt_pk_bf16_f32 v63, v108, v109
    v_lshlrev_b32 v102, 16, v64
    v_and_b32 v103, 0xffff0000, v64
    v_lshlrev_b32 v104, 16, v65
    v_and_b32 v105, 0xffff0000, v65
    v_lshlrev_b32 v106, 16, v66
    v_and_b32 v107, 0xffff0000, v66
    v_lshlrev_b32 v108, 16, v67
    v_and_b32 v109, 0xffff0000, v67
    v_pk_fma_f32 v[102:103], v[102:103], v[96:97], v[98:99] op_sel_hi:[1,0,0]
    v_pk_fma_f32 v[104:105], v[104:105], v[96:97], v[98:99] op_sel_hi:[1,0,0]
    v_pk_fma_f32 v[106:107], v[106:107], v[96:97], v[98:99] op_sel_hi:[1,0,0]
    v_pk_fma_f32 v[108:109], v[108:109], v[96:97], v[98:99] op_sel_hi:[1,0,0]
    v_cvt_pk_bf16_f32 v64, v102, v103
    v_cvt_pk_bf16_f32 v65, v104, v105
    v_cvt_pk_bf16_f32 v66, v106, v107
    v_cvt_pk_bf16_f32 v67, v108, v109
    v_lshlrev_b32 v102, 16, v68
    v_and_b32 v103, 0xffff0000, v68
    v_lshlrev_b32 v104, 16, v69
    v_and_b32 v105, 0xffff0000, v69
    v_lshlrev_b32 v106, 16, v70
    v_and_b32 v107, 0xffff0000, v70
    v_lshlrev_b32 v108, 16, v71
    v_and_b32 v109, 0xffff0000, v71
    v_pk_fma_f32 v[102:103], v[102:103], v[96:97], v[98:99] op_sel_hi:[1,0,0]
    v_pk_fma_f32 v[104:105], v[104:105], v[96:97], v[98:99] op_sel_hi:[1,0,0]
    v_pk_fma_f32 v[106:107], v[106:107], v[96:97], v[98:99] op_sel_hi:[1,0,0]
    v_pk_fma_f32 v[108:109], v[108:109], v[96:97], v[98:99] op_sel_hi:[1,0,0]
    v_cvt_pk_bf16_f32 v68, v102, v103
    v_cvt_pk_bf16_f32 v69, v104, v105
    v_cvt_pk_bf16_f32 v70, v106, v107
    v_cvt_pk_bf16_f32 v71, v108, v109
    v_lshlrev_b32 v102, 16, v72
    v_and_b32 v103, 0xffff0000, v72
    v_lshlrev_b32 v104, 16, v73
    v_and_b32 v105, 0xffff0000, v73
    v_lshlrev_b32 v106, 16, v74
    v_and_b32 v107, 0xffff0000, v74
    v_lshlrev_b32 v108, 16, v75
    v_and_b32 v109, 0xffff0000, v75
    v_pk_fma_f32 v[102:103], v[102:103], v[96:97], v[98:99] op_sel_hi:[1,0,0]
    v_pk_fma_f32 v[104:105], v[104:105], v[96:97], v[98:99] op_sel_hi:[1,0,0]
    v_pk_fma_f32 v[106:107], v[106:107], v[96:97], v[98:99] op_sel_hi:[1,0,0]
    v_pk_fma_f32 v[108:109], v[108:109], v[96:97], v[98:99] op_sel_hi:[1,0,0]
    v_cvt_pk_bf16_f32 v72, v102, v103
    v_cvt_pk_bf16_f32 v73, v104, v105
    v_cvt_pk_bf16_f32 v74, v106, v107
    v_cvt_pk_bf16_f32 v75, v108, v109
    v_lshlrev_b32 v102, 16, v76
    v_and_b32 v103, 0xffff0000, v76
    v_lshlrev_b32 v104, 16, v77
    v_and_b32 v105, 0xffff0000, v77
    v_lshlrev_b32 v106, 16, v78
    v_and_b32 v107, 0xffff0000, v78
    v_lshlrev_b32 v108, 16, v79
    v_and_b32 v109, 0xffff0000, v79
    v_pk_fma_f32 v[102:103], v[102:103], v[96:97], v[98:99] op_sel_hi:[1,0,0]
    v_pk_fma_f32 v[104:105], v[104:105], v[96:97], v[98:99] op_sel_hi:[1,0,0]
    v_pk_fma_f32 v[106:107], v[106:107], v[96:97], v[98:99] op_sel_hi:[1,0,0]
    v_pk_fma_f32 v[108:109], v[108:109], v[96:97], v[98:99] op_sel_hi:[1,0,0]
    v_cvt_pk_bf16_f32 v76, v102, v103
    v_cvt_pk_bf16_f32 v77, v104, v105
    v_cvt_pk_bf16_f32 v78, v106, v107
    v_cvt_pk_bf16_f32 v79, v108, v109
    v_lshlrev_b32 v102, 16, v80
    v_and_b32 v103, 0xffff0000, v80
    v_lshlrev_b32 v104, 16, v81
    v_and_b32 v105, 0xffff0000, v81
    v_lshlrev_b32 v106, 16, v82
    v_and_b32 v107, 0xffff0000, v82
    v_lshlrev_b32 v108, 16, v83
    v_and_b32 v109, 0xffff0000, v83
    v_pk_fma_f32 v[102:103], v[102:103], v[96:97], v[98:99] op_sel_hi:[1,0,0]
    v_pk_fma_f32 v[104:105], v[104:105], v[96:97], v[98:99] op_sel_hi:[1,0,0]
    v_pk_fma_f32 v[106:107], v[106:107], v[96:97], v[98:99] op_sel_hi:[1,0,0]
    v_pk_fma_f32 v[108:109], v[108:109], v[96:97], v[98:99] op_sel_hi:[1,0,0]
    v_cvt_pk_bf16_f32 v80, v102, v103
    v_cvt_pk_bf16_f32 v81, v104, v105
    v_cvt_pk_bf16_f32 v82, v106, v107
    v_cvt_pk_bf16_f32 v83, v108, v109
    v_lshlrev_b32 v102, 16, v84
    v_and_b32 v103, 0xffff0000, v84
    v_lshlrev_b32 v104, 16, v85
    v_and_b32 v105, 0xffff0000, v85
    v_lshlrev_b32 v106, 16, v86
    v_and_b32 v107, 0xffff0000, v86
    v_lshlrev_b32 v108, 16, v87
    v_and_b32 v109, 0xffff0000, v87
    v_pk_fma_f32 v[102:103], v[102:103], v[96:97], v[98:99] op_sel_hi:[1,0,0]
    v_pk_fma_f32 v[104:105], v[104:105], v[96:97], v[98:99] op_sel_hi:[1,0,0]
    v_pk_fma_f32 v[106:107], v[106:107], v[96:97], v[98:99] op_sel_hi:[1,0,0]
    v_pk_fma_f32 v[108:109], v[108:109], v[96:97], v[98:99] op_sel_hi:[1,0,0]
    v_cvt_pk_bf16_f32 v84, v102, v103
    v_cvt_pk_bf16_f32 v85, v104, v105
    v_cvt_pk_bf16_f32 v86, v106, v107
    v_cvt_pk_bf16_f32 v87, v108, v109
    v_lshlrev_b32 v102, 16, v88
    v_and_b32 v103, 0xffff0000, v88
    v_lshlrev_b32 v104, 16, v89
    v_and_b32 v105, 0xffff0000, v89
    v_lshlrev_b32 v106, 16, v90
    v_and_b32 v107, 0xffff0000, v90
    v_lshlrev_b32 v108, 16, v91
    v_and_b32 v109, 0xffff0000, v91
    v_pk_fma_f32 v[102:103], v[102:103], v[96:97], v[98:99] op_sel_hi:[1,0,0]
    v_pk_fma_f32 v[104:105], v[104:105], v[96:97], v[98:99] op_sel_hi:[1,0,0]
    v_pk_fma_f32 v[106:107], v[106:107], v[96:97], v[98:99] op_sel_hi:[1,0,0]
    v_pk_fma_f32 v[108:109], v[108:109], v[96:97], v[98:99] op_sel_hi:[1,0,0]
    v_cvt_pk_bf16_f32 v88, v102, v103
    v_cvt_pk_bf16_f32 v89, v104, v105
    v_cvt_pk_bf16_f32 v90, v106, v107
    v_cvt_pk_bf16_f32 v91, v108, v109
    s_waitcnt lgkmcnt(0)
    s_mov_b32 s18, s11
    s_xor_b32 s11, s11, 0x5bd1e995
    s_mul_i32 s11, s11, 0x9e3779b1
    s_add_u32 s11, s11, 0x7f4a7c15
    s_cmp_eq_u32 s11, s18
    s_addc_u32 s11, s11, 0
    s_cmp_lg_u32 s10, s36
    s_cbranch_scc1 L_q
    s_setprio 3
    s_mov_b32 s40, 0
L_sp1:
    ds_read_b32 v4, v8 offset:28
    s_add_u32 s40, s40, 1
    s_waitcnt lgkmcnt(0)
    v_readfirstlane_b32 s39, v4
    s_cmp_ge_u32 s40, 1048576
    s_cbranch_scc1 L_sp1_ok
    s_cmp_ge_u32 s39, 3
    s_cbranch_scc0 L_sp1
L_sp1_ok:
    v_mov_b32 v184, 0
    v_mov_b32 v185, 0
    v_mov_b32 v186, 0
    v_mov_b32 v187, 0
    v_mov_b32 v188, 0
    v_mov_b32 v189, 0
    v_mov_b32 v190, 0
    v_mov_b32 v191, 0
    s_mul_i32 s39, s44, 1280
    v_add_u32 v180, s39, v180
    s_mov_b32 s45, s44
    s_mov_b32 s46, 4294942976
    s_mov_b32 s47, 1280
    s_and_b32 s39, s9, 1
    s_cmp_eq_u32 s39, 1
    s_cbranch_scc1 L_v
    ds_read_b64_tr_b16 v[120:121], v180 offset:0
    ds_read_b64_tr_b16 v[122:123], v180 offset:160
    ds_read_b64_tr_b16 v[124:125], v180 offset:32
    ds_read_b64_tr_b16 v[126:127], v180 offset:192
    s_add_u32 s45, s45, 1
    s_cmp_eq_u32 s45, 20
    s_cselect_b32 s39, s46, s47
    s_cselect_b32 s45, 0, s45
    v_add_u32 v180, s39, v180
    ds_read_b64_tr_b16 v[128:129], v180 offset:0
    ds_read_b64_tr_b16 v[130:131], v180 offset:160
    ds_read_b64_tr_b16 v[132:133], v180 offset:32
    ds_read_b64_tr_b16 v[134:135], v180 offset:192
    s_add_u32 s45, s45, 1
    s_cmp_eq_u32 s45, 20
    s_cselect_b32 s39, s46, s47
    s_cselect_b32 s45, 0, s45
    v_add_u32 v180, s39, v180
    s_waitcnt lgkmcnt(4)
    v_mfma_f32_16x16x32_bf16 v[184:187], v[120:123], v[12:15], v[184:187]
    v_mfma_f32_16x16x32_bf16 v[188:191], v[124:127], v[12:15], v[188:191]
    ds_read_b64_tr_b16 v[120:121], v180 offset:0
    ds_read_b64_tr_b16 v[122:123], v180 offset:160
    ds_read_b64_tr_b16 v[124:125], v180 offset:32
    ds_read_b64_tr_b16 v[126:127], v180 offset:192
    s_add_u32 s45, s45, 1
    s_cmp_eq_u32 s45, 20
    s_cselect_b32 s39, s46, s47
    s_cselect_b32 s45, 0, s45
    v_add_u32 v180, s39, v180
    s_waitcnt lgkmcnt(4)
    v_mfma_f32_16x16x32_bf16 v[184:187], v[128:131], v[16:19], v[184:187]
    v_mfma_f32_16x16x32_bf16 v[188:191], v[132:135], v[16:19], v[188:191]
    ds_read_b64_tr_b16 v[128:129], v180 offset:0
    ds_read_b64_tr_b16 v[130:131], v180 offset:160
    ds_read_b64_tr_b16 v[132:133], v180 offset:32
    ds_read_b64_tr_b16 v[134:135], v180 offset:192
    s_add_u32 s45, s45, 1
    s_cmp_eq_u32 s45, 20
    s_cselect_b32 s39, s46, s47
    s_cselect_b32 s45, 0, s45
    v_add_u32 v180, s39, v180
    s_waitcnt lgkmcnt(4)
    v_mfma_f32_16x16x32_bf16 v[184:187], v[120:123], v[20:23], v[184:187]
    v_mfma_f32_16x16x32_bf16 v[188:191], v[124:127], v[20:23], v[188:191]
    ds_read_b64_tr_b16 v[120:121], v180 offset:0
    ds_read_b64_tr_b16 v[122:123], v180 offset:160
    ds_read_b64_tr_b16 v[124:125], v180 offset:32
    ds_read_b64_tr_b16 v[126:127], v180 offset:192
    s_add_u32 s45, s45, 1
    s_cmp_eq_u32 s45, 20
    s_cselect_b32 s39, s46, s47
    s_cselect_b32 s45, 0, s45
    v_add_u32 v180, s39, v180
    s_waitcnt lgkmcnt(4)
    v_mfma_f32_16x16x32_bf16 v[184:187], v[128:131], v[24:27], v[184:187]
    v_mfma_f32_16x16x32_bf16 v[188:191], v[132:135], v[24:27], v[188:191]
    ds_read_b64_tr_b16 v[128:129], v180 offset:0
    ds_read_b64_tr_b16 v[130:131], v180 offset:160
    ds_read_b64_tr_b16 v[132:133], v180 offset:32
    ds_read_b64_tr_b16 v[134:135], v180 offset:192
    s_add_u32 s45, s45, 1
    s_cmp_eq_u32 s45, 20
    s_cselect_b32 s39, s46, s47
    s_cselect_b32 s45, 0, s45
    v_add_u32 v180, s39, v180
    s_waitcnt lgkmcnt(4)
    v_mfma_f32_16x16x32_bf16 v[184:187], v[120:123], v[28:31], v[184:187]
    v_mfma_f32_16x16x32_bf16 v[188:191], v[124:127], v[28:31], v[188:191]
    ds_read_b64_tr_b16 v[120:121], v180 offset:0
    ds_read_b64_tr_b16 v[122:123], v180 offset:160
    ds_read_b64_tr_b16 v[124:125], v180 offset:32
    ds_read_b64_tr_b16 v[126:127], v180 offset:192
    s_add_u32 s45, s45, 1
    s_cmp_eq_u32 s45, 20
    s_cselect_b32 s39, s46, s47
    s_cselect_b32 s45, 0, s45
    v_add_u32 v180, s39, v180
    s_waitcnt lgkmcnt(4)
    v_mfma_f32_16x16x32_bf16 v[184:187], v[128:131], v[32:35], v[184:187]
    v_mfma_f32_16x16x32_bf16 v[188:191], v[132:135], v[32:35], v[188:191]
    ds_read_b64_tr_b16 v[128:129], v180 offset:0
    ds_read_b64_tr_b16 v[130:131], v180 offset:160
    ds_read_b64_tr_b16 v[132:133], v180 offset:32
    ds_read_b64_tr_b16 v[134:135], v180 offset:192
    s_add_u32 s45, s45, 1
    s_cmp_eq_u32 s45, 20
    s_cselect_b32 s39, s46, s47
    s_cselect_b32 s45, 0, s45
    v_add_u32 v180, s39, v180
    s_waitcnt lgkmcnt(4)
    v_mfma_f32_16x16x32_bf16 v[184:187], v[120:123], v[36:39], v[184:187]
    v_mfma_f32_16x16x32_bf16 v[188:191], v[124:127], v[36:39], v[188:191]
    ds_read_b64_tr_b16 v[120:121], v180 offset:0
    ds_read_b64_tr_b16 v[122:123], v180 offset:160
    ds_read_b64_tr_b16 v[124:125], v180 offset:32
    ds_read_b64_tr_b16 v[126:127], v180 offset:192
    s_add_u32 s45, s45, 1
    s_cmp_eq_u32 s45, 20
    s_cselect_b32 s39, s46, s47
    s_cselect_b32 s45, 0, s45
    v_add_u32 v180, s39, v180
    s_waitcnt lgkmcnt(4)
    v_mfma_f32_16x16x32_bf16 v[184:187], v[128:131], v[40:43], v[184:187]
    v_mfma_f32_16x16x32_bf16 v[188:191], v[132:135], v[40:43], v[188:191]
    ds_read_b64_tr_b16 v[128:129], v180 offset:0
    ds_read_b64_tr_b16 v[130:131], v180 offset:160
    ds_read_b64_tr_b16 v[132:133], v180 offset:32
    ds_read_b64_tr_b16 v[134:135], v180 offset:192
    s_add_u32 s45, s45, 1
    s_cmp_eq_u32 s45, 20
    s_cselect_b32 s39, s46, s47
    s_cselect_b32 s45, 0, s45
    v_add_u32 v180, s39, v180
    s_waitcnt lgkmcnt(4)
    v_mfma_f32_16x16x32_bf16 v[184:187], v[120:123], v[44:47], v[184:187]
    v_mfma_f32_16x16x32_bf16 v[188:191], v[124:127], v[44:47], v[188:191]
    ds_read_b64_tr_b16 v[120:121], v180 offset:0
    ds_read_b64_tr_b16 v[122:123], v180 offset:160
    ds_read_b64_tr_b16 v[124:125], v180 offset:32
    ds_read_b64_tr_b16 v[126:127], v180 offset:192
    s_add_u32 s45, s45, 1
    s_cmp_eq_u32 s45, 20
    s_cselect_b32 s39, s46, s47
    s_cselect_b32 s45, 0, s45
    v_add_u32 v180, s39, v180
    s_waitcnt lgkmcnt(4)
    v_mfma_f32_16x16x32_bf16 v[184:187], v[128:131], v[48:51], v[184:187]
    v_mfma_f32_16x16x32_bf16 v[188:191], v[132:135], v[48:51], v[188:191]
    ds_read_b64_tr_b16 v[128:129], v180 offset:0
    ds_read_b64_tr_b16 v[130:131], v180 offset:160
    ds_read_b64_tr_b16 v[132:133], v180 offset:32
    ds_read_b64_tr_b16 v[134:135], v180 offset:192
    s_add_u32 s45, s45, 1
    s_cmp_eq_u32 s45, 20
    s_cselect_b32 s39, s46, s47
    s_cselect_b32 s45, 0, s45
    v_add_u32 v180, s39, v180
    s_waitcnt lgkmcnt(4)
    v_mfma_f32_16x16x32_bf16 v[184:187], v[120:123], v[52:55], v[184:187]
    v_mfma_f32_16x16x32_bf16 v[188:191], v[124:127], v[52:55], v[188:191]
    ds_read_b64_tr_b16 v[120:121], v180 offset:0
    ds_read_b64_tr_b16 v[122:123], v180 offset:160
    ds_read_b64_tr_b16 v[124:125], v180 offset:32
    ds_read_b64_tr_b16 v[126:127], v180 offset:192
    s_add_u32 s45, s45, 1
    s_cmp_eq_u32 s45, 20
    s_cselect_b32 s39, s46, s47
    s_cselect_b32 s45, 0, s45
    v_add_u32 v180, s39, v180
    s_waitcnt lgkmcnt(4)
    v_mfma_f32_16x16x32_bf16 v[184:187], v[128:131], v[56:59], v[184:187]
    v_mfma_f32_16x16x32_bf16 v[188:191], v[132:135], v[56:59], v[188:191]
    ds_read_b64_tr_b16 v[128:129], v180 offset:0
    ds_read_b64_tr_b16 v[130:131], v180 offset:160
    ds_read_b64_tr_b16 v[132:133], v180 offset:32
    ds_read_b64_tr_b16 v[134:135], v180 offset:192
    s_add_u32 s45, s45, 1
    s_cmp_eq_u32 s45, 20
    s_cselect_b32 s39, s46, s47
    s_cselect_b32 s45, 0, s45
    v_add_u32 v180, s39, v180
    s_waitcnt lgkmcnt(4)
    v_mfma_f32_16x16x32_bf16 v[184:187], v[120:123], v[60:63], v[184:187]
    v_mfma_f32_16x16x32_bf16 v[188:191], v[124:127], v[60:63], v[188:191]
    ds_read_b64_tr_b16 v[120:121], v180 offset:0
    ds_read_b64_tr_b16 v[122:123], v180 offset:160
    ds_read_b64_tr_b16 v[124:125], v180 offset:32
    ds_read_b64_tr_b16 v[126:127], v180 offset:192
    s_add_u32 s45, s45, 1
    s_cmp_eq_u32 s45, 20
    s_cselect_b32 s39, s46, s47
    s_cselect_b32 s45, 0, s45
    v_add_u32 v180, s39, v180
    s_waitcnt lgkmcnt(4)
    v_mfma_f32_16x16x32_bf16 v[184:187], v[128:131], v[64:67], v[184:187]
    v_mfma_f32_16x16x32_bf16 v[188:191], v[132:135], v[64:67], v[188:191]
    ds_read_b64_tr_b16 v[128:129], v180 offset:0
    ds_read_b64_tr_b16 v[130:131], v180 offset:160
    ds_read_b64_tr_b16 v[132:133], v180 offset:32
    ds_read_b64_tr_b16 v[134:135], v180 offset:192
    s_add_u32 s45, s45, 1
    s_cmp_eq_u32 s45, 20
    s_cselect_b32 s39, s46, s47
    s_cselect_b32 s45, 0, s45
    v_add_u32 v180, s39, v180
    s_waitcnt lgkmcnt(4)
    v_mfma_f32_16x16x32_bf16 v[184:187], v[120:123], v[68:71], v[184:187]
    v_mfma_f32_16x16x32_bf16 v[188:191], v[124:127], v[68:71], v[188:191]
    ds_read_b64_tr_b16 v[120:121], v180 offset:0
    ds_read_b64_tr_b16 v[122:123], v180 offset:160
    ds_read_b64_tr_b16 v[124:125], v180 offset:32
    ds_read_b64_tr_b16 v[126:127], v180 offset:192
    s_add_u32 s45, s45, 1
    s_cmp_eq_u32 s45, 20
    s_cselect_b32 s39, s46, s47
    s_cselect_b32 s45, 0, s45
    v_add_u32 v180, s39, v180
    s_waitcnt lgkmcnt(4)
    v_mfma_f32_16x16x32_bf16 v[184:187], v[128:131], v[72:75], v[184:187]
    v_mfma_f32_16x16x32_bf16 v[188:191], v[132:135], v[72:75], v[188:191]
    ds_read_b64_tr_b16 v[128:129], v180 offset:0
    ds_read_b64_tr_b16 v[130:131], v180 offset:160
    ds_read_b64_tr_b16 v[132:133], v180 offset:32
    ds_read_b64_tr_b16 v[134:135], v180 offset:192
    s_add_u32 s45, s45, 1
    s_cmp_eq_u32 s45, 20
    s_cselect_b32 s39, s46, s47
    s_cselect_b32 s45, 0, s45
    v_add_u32 v180, s39, v180
    s_waitcnt lgkmcnt(4)
    v_mfma_f32_16x16x32_bf16 v[184:187], v[120:123], v[76:79], v[184:187]
    v_mfma_f32_16x16x32_bf16 v[188:191], v[124:127], v[76:79], v[188:191]
    ds_read_b64_tr_b16 v[120:121], v180 offset:0
    ds_read_b64_tr_b16 v[122:123], v180 offset:160
    ds_read_b64_tr_b16 v[124:125], v180 offset:32
    ds_read_b64_tr_b16 v[126:127], v180 offset:192
    s_add_u32 s45, s45, 1
    s_cmp_eq_u32 s45, 20
    s_cselect_b32 s39, s46, s47
    s_cselect_b32 s45, 0, s45
    v_add_u32 v180, s39, v180
    s_waitcnt lgkmcnt(4)
    v_mfma_f32_16x16x32_bf16 v[184:187], v[128:131], v[80:83], v[184:187]
    v_mfma_f32_16x16x32_bf16 v[188:191], v[132:135], v[80:83], v[188:191]
    ds_read_b64_tr_b16 v[128:129], v180 offset:0
    ds_read_b64_tr_b16 v[130:131], v180 offset:160
    ds_read_b64_tr_b16 v[132:133], v180 offset:32
    ds_read_b64_tr_b16 v[134:135], v180 offset:192
    s_add_u32 s45, s45, 1
    s_cmp_eq_u32 s45, 20
    s_cselect_b32 s39, s46, s47
    s_cselect_b32 s45, 0, s45
    v_add_u32 v180, s39, v180
    s_waitcnt lgkmcnt(4)
    v_mfma_f32_16x16x32_bf16 v[184:187], v[120:123], v[84:87], v[184:187]
    v_mfma_f32_16x16x32_bf16 v[188:191], v[124:127], v[84:87], v[188:191]
    s_waitcnt lgkmcnt(0)
    v_mfma_f32_16x16x32_bf16 v[184:187], v[128:131], v[88:91], v[184:187]
    v_mfma_f32_16x16x32_bf16 v[188:191], v[132:135], v[88:91], v[188:191]
    s_nop 7
    v_cvt_pk_bf16_f32 v120, v184, v185
    v_cvt_pk_bf16_f32 v121, v186, v187
    v_cvt_pk_bf16_f32 v122, v188, v189
    v_cvt_pk_bf16_f32 v123, v190, v191
    v_lshrrev_b32 v4, 1, v2
    v_lshlrev_b32 v4, 9, v4
    v_lshl_add_u32 v4, v181, 4, v4
    v_and_b32 v5, 1, v2
    v_lshl_add_u32 v4, v5, 3, v4
    buffer_store_dwordx2 v[120:121], v4, s[4:7], s42 offen sc1
    v_lshlrev_b32 v5, 3, v181
    s_mov_b64 exec, 0xffff
    buffer_store_dwordx2 v[122:123], v5, s[4:7], s42 offen offset:1024 sc1
    s_mov_b64 exec, -1
    v_mul_f32 v92, v184, v184
    v_fmac_f32 v92, v185, v185
    v_fmac_f32 v92, v186, v186
    v_fmac_f32 v92, v187, v187
    v_mul_f32 v94, v188, v188
    v_fmac_f32 v94, v189, v189
    v_fmac_f32 v94, v190, v190
    v_fmac_f32 v94, v191, v191
    v_cmp_eq_u32 vcc, 0, v2
    s_nop 1
    v_cndmask_b32 v94, 0, v94, vcc
    v_add_f32 v92, v92, v94
    v_mov_b32 v6, v92
    s_nop 1
    v_permlane16_swap_b32 v92, v6
    s_nop 0
    v_add_f32 v92, v92, v6
    v_mov_b32 v6, v92
    s_nop 1
    v_permlane32_swap_b32 v92, v6
    s_nop 0
    v_add_f32 v92, v92, v6
    s_nop 1
    v_max_f32_dpp v92, v92, v92 row_ror:8 row_mask:0xf bank_mask:0xf
    s_nop 1
    v_max_f32_dpp v92, v92, v92 row_ror:4 row_mask:0xf bank_mask:0xf
    s_nop 1
    v_max_f32_dpp v92, v92, v92 row_ror:2 row_mask:0xf bank_mask:0xf
    s_nop 1
    v_max_f32_dpp v92, v92, v92 row_ror:1 row_mask:0xf bank_mask:0xf
    s_lshl_b32 s40, s37, 2
    s_add_u32 s40, s40, 20480
    v_mov_b32 v6, 0
    s_mov_b64 exec, 1
    buffer_store_dword v92, v6, s[4:7], s40 offen sc1
    s_mov_b64 exec, -1
    s_branch L_kv_pub
L_v:
    ds_read_b64_tr_b16 v[120:121], v180 offset:0
    ds_read_b64_tr_b16 v[122:123], v180 offset:160
    ds_read_b64_tr_b16 v[124:125], v180 offset:32
    ds_read_b64_tr_b16 v[126:127], v180 offset:192
    s_add_u32 s45, s45, 1
    s_cmp_eq_u32 s45, 20
    s_cselect_b32 s39, s46, s47
    s_cselect_b32 s45, 0, s45
    v_add_u32 v180, s39, v180
    ds_read_b64_tr_b16 v[128:129], v180 offset:0
    ds_read_b64_tr_b16 v[130:131], v180 offset:160
    ds_read_b64_tr_b16 v[132:133], v180 offset:32
    ds_read_b64_tr_b16 v[134:135], v180 offset:192
    s_add_u32 s45, s45, 1
    s_cmp_eq_u32 s45, 20
    s_cselect_b32 s39, s46, s47
    s_cselect_b32 s45, 0, s45
    v_add_u32 v180, s39, v180
    s_waitcnt lgkmcnt(4)
    v_mfma_f32_16x16x32_bf16 v[184:187], v[12:15], v[120:123], v[184:187]
    v_mfma_f32_16x16x32_bf16 v[188:191], v[12:15], v[124:127], v[188:191]
    ds_read_b64_tr_b16 v[120:121], v180 offset:0
    ds_read_b64_tr_b16 v[122:123], v180 offset:160
    ds_read_b64_tr_b16 v[124:125], v180 offset:32
    ds_read_b64_tr_b16 v[126:127], v180 offset:192
    s_add_u32 s45, s45, 1
    s_cmp_eq_u32 s45, 20
    s_cselect_b32 s39, s46, s47
    s_cselect_b32 s45, 0, s45
    v_add_u32 v180, s39, v180
    s_waitcnt lgkmcnt(4)
    v_mfma_f32_16x16x32_bf16 v[184:187], v[16:19], v[128:131], v[184:187]
    v_mfma_f32_16x16x32_bf16 v[188:191], v[16:19], v[132:135], v[188:191]
    ds_read_b64_tr_b16 v[128:129], v180 offset:0
    ds_read_b64_tr_b16 v[130:131], v180 offset:160
    ds_read_b64_tr_b16 v[132:133], v180 offset:32
    ds_read_b64_tr_b16 v[134:135], v180 offset:192
    s_add_u32 s45, s45, 1
    s_cmp_eq_u32 s45, 20
    s_cselect_b32 s39, s46, s47
    s_cselect_b32 s45, 0, s45
    v_add_u32 v180, s39, v180
    s_waitcnt lgkmcnt(4)
    v_mfma_f32_16x16x32_bf16 v[184:187], v[20:23], v[120:123], v[184:187]
    v_mfma_f32_16x16x32_bf16 v[188:191], v[20:23], v[124:127], v[188:191]
    ds_read_b64_tr_b16 v[120:121], v180 offset:0
    ds_read_b64_tr_b16 v[122:123], v180 offset:160
    ds_read_b64_tr_b16 v[124:125], v180 offset:32
    ds_read_b64_tr_b16 v[126:127], v180 offset:192
    s_add_u32 s45, s45, 1
    s_cmp_eq_u32 s45, 20
    s_cselect_b32 s39, s46, s47
    s_cselect_b32 s45, 0, s45
    v_add_u32 v180, s39, v180
    s_waitcnt lgkmcnt(4)
    v_mfma_f32_16x16x32_bf16 v[184:187], v[24:27], v[128:131], v[184:187]
    v_mfma_f32_16x16x32_bf16 v[188:191], v[24:27], v[132:135], v[188:191]
    ds_read_b64_tr_b16 v[128:129], v180 offset:0
    ds_read_b64_tr_b16 v[130:131], v180 offset:160
    ds_read_b64_tr_b16 v[132:133], v180 offset:32
    ds_read_b64_tr_b16 v[134:135], v180 offset:192
    s_add_u32 s45, s45, 1
    s_cmp_eq_u32 s45, 20
    s_cselect_b32 s39, s46, s47
    s_cselect_b32 s45, 0, s45
    v_add_u32 v180, s39, v180
    s_waitcnt lgkmcnt(4)
    v_mfma_f32_16x16x32_bf16 v[184:187], v[28:31], v[120:123], v[184:187]
    v_mfma_f32_16x16x32_bf16 v[188:191], v[28:31], v[124:127], v[188:191]
    ds_read_b64_tr_b16 v[120:121], v180 offset:0
    ds_read_b64_tr_b16 v[122:123], v180 offset:160
    ds_read_b64_tr_b16 v[124:125], v180 offset:32
    ds_read_b64_tr_b16 v[126:127], v180 offset:192
    s_add_u32 s45, s45, 1
    s_cmp_eq_u32 s45, 20
    s_cselect_b32 s39, s46, s47
    s_cselect_b32 s45, 0, s45
    v_add_u32 v180, s39, v180
    s_waitcnt lgkmcnt(4)
    v_mfma_f32_16x16x32_bf16 v[184:187], v[32:35], v[128:131], v[184:187]
    v_mfma_f32_16x16x32_bf16 v[188:191], v[32:35], v[132:135], v[188:191]
    ds_read_b64_tr_b16 v[128:129], v180 offset:0
    ds_read_b64_tr_b16 v[130:131], v180 offset:160
    ds_read_b64_tr_b16 v[132:133], v180 offset:32
    ds_read_b64_tr_b16 v[134:135], v180 offset:192
    s_add_u32 s45, s45, 1
    s_cmp_eq_u32 s45, 20
    s_cselect_b32 s39, s46, s47
    s_cselect_b32 s45, 0, s45
    v_add_u32 v180, s39, v180
    s_waitcnt lgkmcnt(4)
    v_mfma_f32_16x16x32_bf16 v[184:187], v[36:39], v[120:123], v[184:187]
    v_mfma_f32_16x16x32_bf16 v[188:191], v[36:39], v[124:127], v[188:191]
    ds_read_b64_tr_b16 v[120:121], v180 offset:0
    ds_read_b64_tr_b16 v[122:123], v180 offset:160
    ds_read_b64_tr_b16 v[124:125], v180 offset:32
    ds_read_b64_tr_b16 v[126:127], v180 offset:192
    s_add_u32 s45, s45, 1
    s_cmp_eq_u32 s45, 20
    s_cselect_b32 s39, s46, s47
    s_cselect_b32 s45, 0, s45
    v_add_u32 v180, s39, v180
    s_waitcnt lgkmcnt(4)
    v_mfma_f32_16x16x32_bf16 v[184:187], v[40:43], v[128:131], v[184:187]
    v_mfma_f32_16x16x32_bf16 v[188:191], v[40:43], v[132:135], v[188:191]
    ds_read_b64_tr_b16 v[128:129], v180 offset:0
    ds_read_b64_tr_b16 v[130:131], v180 offset:160
    ds_read_b64_tr_b16 v[132:133], v180 offset:32
    ds_read_b64_tr_b16 v[134:135], v180 offset:192
    s_add_u32 s45, s45, 1
    s_cmp_eq_u32 s45, 20
    s_cselect_b32 s39, s46, s47
    s_cselect_b32 s45, 0, s45
    v_add_u32 v180, s39, v180
    s_waitcnt lgkmcnt(4)
    v_mfma_f32_16x16x32_bf16 v[184:187], v[44:47], v[120:123], v[184:187]
    v_mfma_f32_16x16x32_bf16 v[188:191], v[44:47], v[124:127], v[188:191]
    ds_read_b64_tr_b16 v[120:121], v180 offset:0
    ds_read_b64_tr_b16 v[122:123], v180 offset:160
    ds_read_b64_tr_b16 v[124:125], v180 offset:32
    ds_read_b64_tr_b16 v[126:127], v180 offset:192
    s_add_u32 s45, s45, 1
    s_cmp_eq_u32 s45, 20
    s_cselect_b32 s39, s46, s47
    s_cselect_b32 s45, 0, s45
    v_add_u32 v180, s39, v180
    s_waitcnt lgkmcnt(4)
    v_mfma_f32_16x16x32_bf16 v[184:187], v[48:51], v[128:131], v[184:187]
    v_mfma_f32_16x16x32_bf16 v[188:191], v[48:51], v[132:135], v[188:191]
    ds_read_b64_tr_b16 v[128:129], v180 offset:0
    ds_read_b64_tr_b16 v[130:131], v180 offset:160
    ds_read_b64_tr_b16 v[132:133], v180 offset:32
    ds_read_b64_tr_b16 v[134:135], v180 offset:192
    s_add_u32 s45, s45, 1
    s_cmp_eq_u32 s45, 20
    s_cselect_b32 s39, s46, s47
    s_cselect_b32 s45, 0, s45
    v_add_u32 v180, s39, v180
    s_waitcnt lgkmcnt(4)
    v_mfma_f32_16x16x32_bf16 v[184:187], v[52:55], v[120:123], v[184:187]
    v_mfma_f32_16x16x32_bf16 v[188:191], v[52:55], v[124:127], v[188:191]
    ds_read_b64_tr_b16 v[120:121], v180 offset:0
    ds_read_b64_tr_b16 v[122:123], v180 offset:160
    ds_read_b64_tr_b16 v[124:125], v180 offset:32
    ds_read_b64_tr_b16 v[126:127], v180 offset:192
    s_add_u32 s45, s45, 1
    s_cmp_eq_u32 s45, 20
    s_cselect_b32 s39, s46, s47
    s_cselect_b32 s45, 0, s45
    v_add_u32 v180, s39, v180
    s_waitcnt lgkmcnt(4)
    v_mfma_f32_16x16x32_bf16 v[184:187], v[56:59], v[128:131], v[184:187]
    v_mfma_f32_16x16x32_bf16 v[188:191], v[56:59], v[132:135], v[188:191]
    ds_read_b64_tr_b16 v[128:129], v180 offset:0
    ds_read_b64_tr_b16 v[130:131], v180 offset:160
    ds_read_b64_tr_b16 v[132:133], v180 offset:32
    ds_read_b64_tr_b16 v[134:135], v180 offset:192
    s_add_u32 s45, s45, 1
    s_cmp_eq_u32 s45, 20
    s_cselect_b32 s39, s46, s47
    s_cselect_b32 s45, 0, s45
    v_add_u32 v180, s39, v180
    s_waitcnt lgkmcnt(4)
    v_mfma_f32_16x16x32_bf16 v[184:187], v[60:63], v[120:123], v[184:187]
    v_mfma_f32_16x16x32_bf16 v[188:191], v[60:63], v[124:127], v[188:191]
    ds_read_b64_tr_b16 v[120:121], v180 offset:0
    ds_read_b64_tr_b16 v[122:123], v180 offset:160
    ds_read_b64_tr_b16 v[124:125], v180 offset:32
    ds_read_b64_tr_b16 v[126:127], v180 offset:192
    s_add_u32 s45, s45, 1
    s_cmp_eq_u32 s45, 20
    s_cselect_b32 s39, s46, s47
    s_cselect_b32 s45, 0, s45
    v_add_u32 v180, s39, v180
    s_waitcnt lgkmcnt(4)
    v_mfma_f32_16x16x32_bf16 v[184:187], v[64:67], v[128:131], v[184:187]
    v_mfma_f32_16x16x32_bf16 v[188:191], v[64:67], v[132:135], v[188:191]
    ds_read_b64_tr_b16 v[128:129], v180 offset:0
    ds_read_b64_tr_b16 v[130:131], v180 offset:160
    ds_read_b64_tr_b16 v[132:133], v180 offset:32
    ds_read_b64_tr_b16 v[134:135], v180 offset:192
    s_add_u32 s45, s45, 1
    s_cmp_eq_u32 s45, 20
    s_cselect_b32 s39, s46, s47
    s_cselect_b32 s45, 0, s45
    v_add_u32 v180, s39, v180
    s_waitcnt lgkmcnt(4)
    v_mfma_f32_16x16x32_bf16 v[184:187], v[68:71], v[120:123], v[184:187]
    v_mfma_f32_16x16x32_bf16 v[188:191], v[68:71], v[124:127], v[188:191]
    ds_read_b64_tr_b16 v[120:121], v180 offset:0
    ds_read_b64_tr_b16 v[122:123], v180 offset:160
    ds_read_b64_tr_b16 v[124:125], v180 offset:32
    ds_read_b64_tr_b16 v[126:127], v180 offset:192
    s_add_u32 s45, s45, 1
    s_cmp_eq_u32 s45, 20
    s_cselect_b32 s39, s46, s47
    s_cselect_b32 s45, 0, s45
    v_add_u32 v180, s39, v180
    s_waitcnt lgkmcnt(4)
    v_mfma_f32_16x16x32_bf16 v[184:187], v[72:75], v[128:131], v[184:187]
    v_mfma_f32_16x16x32_bf16 v[188:191], v[72:75], v[132:135], v[188:191]
    ds_read_b64_tr_b16 v[128:129], v180 offset:0
    ds_read_b64_tr_b16 v[130:131], v180 offset:160
    ds_read_b64_tr_b16 v[132:133], v180 offset:32
    ds_read_b64_tr_b16 v[134:135], v180 offset:192
    s_add_u32 s45, s45, 1
    s_cmp_eq_u32 s45, 20
    s_cselect_b32 s39, s46, s47
    s_cselect_b32 s45, 0, s45
    v_add_u32 v180, s39, v180
    s_waitcnt lgkmcnt(4)
    v_mfma_f32_16x16x32_bf16 v[184:187], v[76:79], v[120:123], v[184:187]
    v_mfma_f32_16x16x32_bf16 v[188:191], v[76:79], v[124:127], v[188:191]
    ds_read_b64_tr_b16 v[120:121], v180 offset:0
    ds_read_b64_tr_b16 v[122:123], v180 offset:160
    ds_read_b64_tr_b16 v[124:125], v180 offset:32
    ds_read_b64_tr_b16 v[126:127], v180 offset:192
    s_add_u32 s45, s45, 1
    s_cmp_eq_u32 s45, 20
    s_cselect_b32 s39, s46, s47
    s_cselect_b32 s45, 0, s45
    v_add_u32 v180, s39, v180
    s_waitcnt lgkmcnt(4)
    v_mfma_f32_16x16x32_bf16 v[184:187], v[80:83], v[128:131], v[184:187]
    v_mfma_f32_16x16x32_bf16 v[188:191], v[80:83], v[132:135], v[188:191]
    ds_read_b64_tr_b16 v[128:129], v180 offset:0
    ds_read_b64_tr_b16 v[130:131], v180 offset:160
    ds_read_b64_tr_b16 v[132:133], v180 offset:32
    ds_read_b64_tr_b16 v[134:135], v180 offset:192
    s_add_u32 s45, s45, 1
    s_cmp_eq_u32 s45, 20
    s_cselect_b32 s39, s46, s47
    s_cselect_b32 s45, 0, s45
    v_add_u32 v180, s39, v180
    s_waitcnt lgkmcnt(4)
    v_mfma_f32_16x16x32_bf16 v[184:187], v[84:87], v[120:123], v[184:187]
    v_mfma_f32_16x16x32_bf16 v[188:191], v[84:87], v[124:127], v[188:191]
    s_waitcnt lgkmcnt(0)
    v_mfma_f32_16x16x32_bf16 v[184:187], v[88:91], v[128:131], v[184:187]
    v_mfma_f32_16x16x32_bf16 v[188:191], v[88:91], v[132:135], v[188:191]
    s_nop 7
    v_cvt_pk_bf16_f32 v120, v184, v185
    v_cvt_pk_bf16_f32 v121, v186, v187
    v_cvt_pk_bf16_f32 v122, v188, v189
    v_cvt_pk_bf16_f32 v123, v190, v191
    s_and_b32 s40, s36, 1
    s_mul_i32 s40, s40, 704
    s_add_u32 s40, s40, s42
    s_add_u32 s40, s40, 1280
    v_and_b32 v5, 1, v2
    v_mul_u32_u24 v5, 352, v5
    v_lshrrev_b32 v6, 1, v2
    v_lshl_add_u32 v5, v6, 3, v5
    v_add_u32 v4, 7, v1
    v_cmp_gt_u32 vcc, 4, v1
    s_nop 1
    v_cndmask_b32 v4, v4, v1, vcc
    v_subrev_u32 v6, 10, v1
    v_cmp_le_u32 vcc, 14, v1
    s_nop 1
    v_cndmask_b32 v4, v4, v6, vcc
    v_lshl_add_u32 v4, v4, 4, v5
    buffer_store_dwordx2 v[120:121], v4, s[4:7], s40 offen sc1
    v_add_u32 v6, 6, v1
    v_lshl_add_u32 v6, v6, 4, v5
    s_mov_b32 exec_lo, 0x000f000f
    s_mov_b32 exec_hi, 0x000f000f
    buffer_store_dwordx2 v[122:123], v6, s[4:7], s40 offen sc1
    s_mov_b64 exec, -1
    v_and_b32 v4, 1, v0
    v_mul_u32_u24 v4, 352, v4
    v_bfe_u32 v5, v0, 1, 1
    v_mul_u32_u24 v6, 176, v5
    v_add_u32 v4, v4, v6
    v_subrev_u32 v5, 1, v5
    v_and_b32 v192, 0x3f803f80, v5
    v_mov_b32 v193, v192
    v_mov_b32 v194, v192
    v_mov_b32 v195, v192
    s_mov_b64 exec, 15
    buffer_store_dwordx4 v[192:195], v4, s[4:7], s40 offen offset:160 sc1
    s_mov_b64 exec, -1
L_kv_pub:
    s_lshl_b32 s39, s8, 3
    s_add_u32 s39, s39, s9
    s_and_b32 s40, s39, 3
    s_lshl_b32 s40, s40, 2
    s_lshr_b32 s39, s39, 2
    s_lshl_b32 s39, s39, 7
    s_add_u32 s39, s39, s40
    s_add_u32 s39, s39, 8388608
    s_waitcnt vmcnt(0)
    v_mov_b32 v4, s11
    v_mov_b32 v5, 0
    s_mov_b64 exec, 1
    buffer_store_dword v4, v5, s[4:7], s39 offen sc1
    s_mov_b64 exec, -1
    s_setprio 0
L_q:
    s_mov_b32 s40, 0
L_sp2:
    ds_read_b32 v4, v8 offset:44
    s_add_u32 s40, s40, 1
    s_waitcnt lgkmcnt(0)
    v_readfirstlane_b32 s39, v4
    s_cmp_ge_u32 s40, 1048576
    s_cbranch_scc1 L_sp2_ok
    s_cmp_ge_u32 s39, 3
    s_cbranch_scc0 L_sp2
L_sp2_ok:
    v_mov_b32 v160, 0
    v_mov_b32 v161, 0
    v_mov_b32 v162, 0
    v_mov_b32 v163, 0
    v_mov_b32 v164, 0
    v_mov_b32 v165, 0
    v_mov_b32 v166, 0
    v_mov_b32 v167, 0
    v_mov_b32 v168, 0
    v_mov_b32 v169, 0
    v_mov_b32 v170, 0
    v_mov_b32 v171, 0
    v_mov_b32 v172, 0
    v_mov_b32 v173, 0
    v_mov_b32 v174, 0
    v_mov_b32 v175, 0
    v_mov_b32 v176, 0
    v_mov_b32 v177, 0
    v_mov_b32 v178, 0
    v_mov_b32 v179, 0
    ds_read_b64_tr_b16 v[120:121], v110 offset:0
    ds_read_b64_tr_b16 v[122:123], v110 offset:2560
    ds_read_b64_tr_b16 v[124:125], v110 offset:32
    ds_read_b64_tr_b16 v[126:127], v110 offset:2592
    ds_read_b64_tr_b16 v[128:129], v110 offset:64
    ds_read_b64_tr_b16 v[130:131], v110 offset:2624
    ds_read_b64_tr_b16 v[132:133], v110 offset:96
    ds_read_b64_tr_b16 v[134:135], v110 offset:2656
    ds_read_b64_tr_b16 v[136:137], v110 offset:128
    ds_read_b64_tr_b16 v[138:139], v110 offset:2688
    ds_read_b64_tr_b16 v[140:141], v110 offset:5120
    ds_read_b64_tr_b16 v[142:143], v110 offset:7680
    ds_read_b64_tr_b16 v[144:145], v110 offset:5152
    ds_read_b64_tr_b16 v[146:147], v110 offset:7712
    s_waitcnt lgkmcnt(4)
    v_mfma_f32_16x16x32_bf16 v[160:163], v[120:123], v[12:15], v[160:163]
    ds_read_b64_tr_b16 v[148:149], v110 offset:5184
    ds_read_b64_tr_b16 v[150:151], v110 offset:7744
    v_mfma_f32_16x16x32_bf16 v[164:167], v[124:127], v[12:15], v[164:167]
    ds_read_b64_tr_b16 v[152:153], v110 offset:5216
    ds_read_b64_tr_b16 v[154:155], v110 offset:7776
    v_mfma_f32_16x16x32_bf16 v[168:171], v[128:131], v[12:15], v[168:171]
    ds_read_b64_tr_b16 v[156:157], v110 offset:5248
    ds_read_b64_tr_b16 v[158:159], v110 offset:7808
    v_mfma_f32_16x16x32_bf16 v[172:175], v[132:135], v[12:15], v[172:175]
    v_mfma_f32_16x16x32_bf16 v[176:179], v[136:139], v[12:15], v[176:179]
    ds_read_b64_tr_b16 v[120:121], v110 offset:10240
    ds_read_b64_tr_b16 v[122:123], v110 offset:12800
    ds_read_b64_tr_b16 v[124:125], v110 offset:10272
    ds_read_b64_tr_b16 v[126:127], v110 offset:12832
    s_waitcnt lgkmcnt(4)
    v_mfma_f32_16x16x32_bf16 v[160:163], v[140:143], v[16:19], v[160:163]
    ds_read_b64_tr_b16 v[128:129], v110 offset:10304
    ds_read_b64_tr_b16 v[130:131], v110 offset:12864
    v_mfma_f32_16x16x32_bf16 v[164:167], v[144:147], v[16:19], v[164:167]
    ds_read_b64_tr_b16 v[132:133], v110 offset:10336
    ds_read_b64_tr_b16 v[134:135], v110 offset:12896
    v_mfma_f32_16x16x32_bf16 v[168:171], v[148:151], v[16:19], v[168:171]
    ds_read_b64_tr_b16 v[136:137], v110 offset:10368
    ds_read_b64_tr_b16 v[138:139], v110 offset:12928
    v_mfma_f32_16x16x32_bf16 v[172:175], v[152:155], v[16:19], v[172:175]
    v_mfma_f32_16x16x32_bf16 v[176:179], v[156:159], v[16:19], v[176:179]
    ds_read_b64_tr_b16 v[140:141], v110 offset:15360
    ds_read_b64_tr_b16 v[142:143], v110 offset:17920
    ds_read_b64_tr_b16 v[144:145], v110 offset:15392
    ds_read_b64_tr_b16 v[146:147], v110 offset:17952
    s_waitcnt lgkmcnt(4)
    v_mfma_f32_16x16x32_bf16 v[160:163], v[120:123], v[20:23], v[160:163]
    ds_read_b64_tr_b16 v[148:149], v110 offset:15424
    ds_read_b64_tr_b16 v[150:151], v110 offset:17984
    v_mfma_f32_16x16x32_bf16 v[164:167], v[124:127], v[20:23], v[164:167]
    ds_read_b64_tr_b16 v[152:153], v110 offset:15456
    ds_read_b64_tr_b16 v[154:155], v110 offset:18016
    v_mfma_f32_16x16x32_bf16 v[168:171], v[128:131], v[20:23], v[168:171]
    ds_read_b64_tr_b16 v[156:157], v110 offset:15488
    ds_read_b64_tr_b16 v[158:159], v110 offset:18048
    v_mfma_f32_16x16x32_bf16 v[172:175], v[132:135], v[20:23], v[172:175]
    v_mfma_f32_16x16x32_bf16 v[176:179], v[136:139], v[20:23], v[176:179]
    ds_read_b64_tr_b16 v[120:121], v110 offset:20480
    ds_read_b64_tr_b16 v[122:123], v110 offset:23040
    ds_read_b64_tr_b16 v[124:125], v110 offset:20512
    ds_read_b64_tr_b16 v[126:127], v110 offset:23072
    s_waitcnt lgkmcnt(4)
    v_mfma_f32_16x16x32_bf16 v[160:163], v[140:143], v[24:27], v[160:163]
    ds_read_b64_tr_b16 v[128:129], v110 offset:20544
    ds_read_b64_tr_b16 v[130:131], v110 offset:23104
    v_mfma_f32_16x16x32_bf16 v[164:167], v[144:147], v[24:27], v[164:167]
    ds_read_b64_tr_b16 v[132:133], v110 offset:20576
    ds_read_b64_tr_b16 v[134:135], v110 offset:23136
    v_mfma_f32_16x16x32_bf16 v[168:171], v[148:151], v[24:27], v[168:171]
    ds_read_b64_tr_b16 v[136:137], v110 offset:20608
    ds_read_b64_tr_b16 v[138:139], v110 offset:23168
    v_mfma_f32_16x16x32_bf16 v[172:175], v[152:155], v[24:27], v[172:175]
    v_mfma_f32_16x16x32_bf16 v[176:179], v[156:159], v[24:27], v[176:179]
    ds_read_b64_tr_b16 v[140:141], v110 offset:25600
    ds_read_b64_tr_b16 v[142:143], v110 offset:28160
    ds_read_b64_tr_b16 v[144:145], v110 offset:25632
    ds_read_b64_tr_b16 v[146:147], v110 offset:28192
    s_waitcnt lgkmcnt(4)
    v_mfma_f32_16x16x32_bf16 v[160:163], v[120:123], v[28:31], v[160:163]
    ds_read_b64_tr_b16 v[148:149], v110 offset:25664
    ds_read_b64_tr_b16 v[150:151], v110 offset:28224
    v_mfma_f32_16x16x32_bf16 v[164:167], v[124:127], v[28:31], v[164:167]
    ds_read_b64_tr_b16 v[152:153], v110 offset:25696
    ds_read_b64_tr_b16 v[154:155], v110 offset:28256
    v_mfma_f32_16x16x32_bf16 v[168:171], v[128:131], v[28:31], v[168:171]
    ds_read_b64_tr_b16 v[156:157], v110 offset:25728
    ds_read_b64_tr_b16 v[158:159], v110 offset:28288
    v_mfma_f32_16x16x32_bf16 v[172:175], v[132:135], v[28:31], v[172:175]
    v_mfma_f32_16x16x32_bf16 v[176:179], v[136:139], v[28:31], v[176:179]
    ds_read_b64_tr_b16 v[120:121], v110 offset:30720
    ds_read_b64_tr_b16 v[122:123], v110 offset:33280
    ds_read_b64_tr_b16 v[124:125], v110 offset:30752
    ds_read_b64_tr_b16 v[126:127], v110 offset:33312
    s_waitcnt lgkmcnt(4)
    v_mfma_f32_16x16x32_bf16 v[160:163], v[140:143], v[32:35], v[160:163]
    ds_read_b64_tr_b16 v[128:129], v110 offset:30784
    ds_read_b64_tr_b16 v[130:131], v110 offset:33344
    v_mfma_f32_16x16x32_bf16 v[164:167], v[144:147], v[32:35], v[164:167]
    ds_read_b64_tr_b16 v[132:133], v110 offset:30816
    ds_read_b64_tr_b16 v[134:135], v110 offset:33376
    v_mfma_f32_16x16x32_bf16 v[168:171], v[148:151], v[32:35], v[168:171]
    ds_read_b64_tr_b16 v[136:137], v110 offset:30848
    ds_read_b64_tr_b16 v[138:139], v110 offset:33408
    v_mfma_f32_16x16x32_bf16 v[172:175], v[152:155], v[32:35], v[172:175]
    v_mfma_f32_16x16x32_bf16 v[176:179], v[156:159], v[32:35], v[176:179]
    ds_read_b64_tr_b16 v[140:141], v110 offset:35840
    ds_read_b64_tr_b16 v[142:143], v110 offset:38400
    ds_read_b64_tr_b16 v[144:145], v110 offset:35872
    ds_read_b64_tr_b16 v[146:147], v110 offset:38432
    s_waitcnt lgkmcnt(4)
    v_mfma_f32_16x16x32_bf16 v[160:163], v[120:123], v[36:39], v[160:163]
    ds_read_b64_tr_b16 v[148:149], v110 offset:35904
    ds_read_b64_tr_b16 v[150:151], v110 offset:38464
    v_mfma_f32_16x16x32_bf16 v[164:167], v[124:127], v[36:39], v[164:167]
    ds_read_b64_tr_b16 v[152:153], v110 offset:35936
    ds_read_b64_tr_b16 v[154:155], v110 offset:38496
    v_mfma_f32_16x16x32_bf16 v[168:171], v[128:131], v[36:39], v[168:171]
    ds_read_b64_tr_b16 v[156:157], v110 offset:35968
    ds_read_b64_tr_b16 v[158:159], v110 offset:38528
    v_mfma_f32_16x16x32_bf16 v[172:175], v[132:135], v[36:39], v[172:175]
    v_mfma_f32_16x16x32_bf16 v[176:179], v[136:139], v[36:39], v[176:179]
    ds_read_b64_tr_b16 v[120:121], v110 offset:40960
    ds_read_b64_tr_b16 v[122:123], v110 offset:43520
    ds_read_b64_tr_b16 v[124:125], v110 offset:40992
    ds_read_b64_tr_b16 v[126:127], v110 offset:43552
    s_waitcnt lgkmcnt(4)
    v_mfma_f32_16x16x32_bf16 v[160:163], v[140:143], v[40:43], v[160:163]
    ds_read_b64_tr_b16 v[128:129], v110 offset:41024
    ds_read_b64_tr_b16 v[130:131], v110 offset:43584
    v_mfma_f32_16x16x32_bf16 v[164:167], v[144:147], v[40:43], v[164:167]
    ds_read_b64_tr_b16 v[132:133], v110 offset:41056
    ds_read_b64_tr_b16 v[134:135], v110 offset:43616
    v_mfma_f32_16x16x32_bf16 v[168:171], v[148:151], v[40:43], v[168:171]
    ds_read_b64_tr_b16 v[136:137], v110 offset:41088
    ds_read_b64_tr_b16 v[138:139], v110 offset:43648
    v_mfma_f32_16x16x32_bf16 v[172:175], v[152:155], v[40:43], v[172:175]
    v_mfma_f32_16x16x32_bf16 v[176:179], v[156:159], v[40:43], v[176:179]
    s_waitcnt lgkmcnt(0)
    s_mov_b32 s40, 0
L_sp3:
    ds_read_b32 v4, v8 offset:48
    s_add_u32 s40, s40, 1
    s_waitcnt lgkmcnt(0)
    v_readfirstlane_b32 s39, v4
    s_cmp_ge_u32 s40, 1048576
    s_cbranch_scc1 L_sp3_ok
    s_cmp_ge_u32 s39, 3
    s_cbranch_scc0 L_sp3
L_sp3_ok:
    ds_read_b64_tr_b16 v[140:141], v110 offset:46080
    ds_read_b64_tr_b16 v[142:143], v110 offset:48640
    ds_read_b64_tr_b16 v[144:145], v110 offset:46112
    ds_read_b64_tr_b16 v[146:147], v110 offset:48672
    s_waitcnt lgkmcnt(4)
    v_mfma_f32_16x16x32_bf16 v[160:163], v[120:123], v[44:47], v[160:163]
    ds_read_b64_tr_b16 v[148:149], v110 offset:46144
    ds_read_b64_tr_b16 v[150:151], v110 offset:48704
    v_mfma_f32_16x16x32_bf16 v[164:167], v[124:127], v[44:47], v[164:167]
    ds_read_b64_tr_b16 v[152:153], v110 offset:46176
    ds_read_b64_tr_b16 v[154:155], v110 offset:48736
    v_mfma_f32_16x16x32_bf16 v[168:171], v[128:131], v[44:47], v[168:171]
    ds_read_b64_tr_b16 v[156:157], v110 offset:46208
    ds_read_b64_tr_b16 v[158:159], v110 offset:48768
    v_mfma_f32_16x16x32_bf16 v[172:175], v[132:135], v[44:47], v[172:175]
    v_mfma_f32_16x16x32_bf16 v[176:179], v[136:139], v[44:47], v[176:179]
    ds_read_b64_tr_b16 v[120:121], v111 offset:0
    ds_read_b64_tr_b16 v[122:123], v111 offset:2560
    ds_read_b64_tr_b16 v[124:125], v111 offset:32
    ds_read_b64_tr_b16 v[126:127], v111 offset:2592
    s_waitcnt lgkmcnt(4)
    v_mfma_f32_16x16x32_bf16 v[160:163], v[140:143], v[48:51], v[160:163]
    ds_read_b64_tr_b16 v[128:129], v111 offset:64
    ds_read_b64_tr_b16 v[130:131], v111 offset:2624
    v_mfma_f32_16x16x32_bf16 v[164:167], v[144:147], v[48:51], v[164:167]
    ds_read_b64_tr_b16 v[132:133], v111 offset:96
    ds_read_b64_tr_b16 v[134:135], v111 offset:2656
    v_mfma_f32_16x16x32_bf16 v[168:171], v[148:151], v[48:51], v[168:171]
    ds_read_b64_tr_b16 v[136:137], v111 offset:128
    ds_read_b64_tr_b16 v[138:139], v111 offset:2688
    v_mfma_f32_16x16x32_bf16 v[172:175], v[152:155], v[48:51], v[172:175]
    v_mfma_f32_16x16x32_bf16 v[176:179], v[156:159], v[48:51], v[176:179]
    ds_read_b64_tr_b16 v[140:141], v111 offset:5120
    ds_read_b64_tr_b16 v[142:143], v111 offset:7680
    ds_read_b64_tr_b16 v[144:145], v111 offset:5152
    ds_read_b64_tr_b16 v[146:147], v111 offset:7712
    s_waitcnt lgkmcnt(4)
    v_mfma_f32_16x16x32_bf16 v[160:163], v[120:123], v[52:55], v[160:163]
    ds_read_b64_tr_b16 v[148:149], v111 offset:5184
    ds_read_b64_tr_b16 v[150:151], v111 offset:7744
    v_mfma_f32_16x16x32_bf16 v[164:167], v[124:127], v[52:55], v[164:167]
    ds_read_b64_tr_b16 v[152:153], v111 offset:5216
    ds_read_b64_tr_b16 v[154:155], v111 offset:7776
    v_mfma_f32_16x16x32_bf16 v[168:171], v[128:131], v[52:55], v[168:171]
    ds_read_b64_tr_b16 v[156:157], v111 offset:5248
    ds_read_b64_tr_b16 v[158:159], v111 offset:7808
    v_mfma_f32_16x16x32_bf16 v[172:175], v[132:135], v[52:55], v[172:175]
    v_mfma_f32_16x16x32_bf16 v[176:179], v[136:139], v[52:55], v[176:179]
    ds_read_b64_tr_b16 v[120:121], v111 offset:10240
    ds_read_b64_tr_b16 v[122:123], v111 offset:12800
    ds_read_b64_tr_b16 v[124:125], v111 offset:10272
    ds_read_b64_tr_b16 v[126:127], v111 offset:12832
    s_waitcnt lgkmcnt(4)
    v_mfma_f32_16x16x32_bf16 v[160:163], v[140:143], v[56:59], v[160:163]
    ds_read_b64_tr_b16 v[128:129], v111 offset:10304
    ds_read_b64_tr_b16 v[130:131], v111 offset:12864
    v_mfma_f32_16x16x32_bf16 v[164:167], v[144:147], v[56:59], v[164:167]
    ds_read_b64_tr_b16 v[132:133], v111 offset:10336
    ds_read_b64_tr_b16 v[134:135], v111 offset:12896
    v_mfma_f32_16x16x32_bf16 v[168:171], v[148:151], v[56:59], v[168:171]
    ds_read_b64_tr_b16 v[136:137], v111 offset:10368
    ds_read_b64_tr_b16 v[138:139], v111 offset:12928
    v_mfma_f32_16x16x32_bf16 v[172:175], v[152:155], v[56:59], v[172:175]
    v_mfma_f32_16x16x32_bf16 v[176:179], v[156:159], v[56:59], v[176:179]
    ds_read_b64_tr_b16 v[140:141], v111 offset:15360
    ds_read_b64_tr_b16 v[142:143], v111 offset:17920
    ds_read_b64_tr_b16 v[144:145], v111 offset:15392
    ds_read_b64_tr_b16 v[146:147], v111 offset:17952
    s_waitcnt lgkmcnt(4)
    v_mfma_f32_16x16x32_bf16 v[160:163], v[120:123], v[60:63], v[160:163]
    ds_read_b64_tr_b16 v[148:149], v111 offset:15424
    ds_read_b64_tr_b16 v[150:151], v111 offset:17984
    v_mfma_f32_16x16x32_bf16 v[164:167], v[124:127], v[60:63], v[164:167]
    ds_read_b64_tr_b16 v[152:153], v111 offset:15456
    ds_read_b64_tr_b16 v[154:155], v111 offset:18016
    v_mfma_f32_16x16x32_bf16 v[168:171], v[128:131], v[60:63], v[168:171]
    ds_read_b64_tr_b16 v[156:157], v111 offset:15488
    ds_read_b64_tr_b16 v[158:159], v111 offset:18048
    v_mfma_f32_16x16x32_bf16 v[172:175], v[132:135], v[60:63], v[172:175]
    v_mfma_f32_16x16x32_bf16 v[176:179], v[136:139], v[60:63], v[176:179]
    ds_read_b64_tr_b16 v[120:121], v111 offset:20480
    ds_read_b64_tr_b16 v[122:123], v111 offset:23040
    ds_read_b64_tr_b16 v[124:125], v111 offset:20512
    ds_read_b64_tr_b16 v[126:127], v111 offset:23072
    s_waitcnt lgkmcnt(4)
    v_mfma_f32_16x16x32_bf16 v[160:163], v[140:143], v[64:67], v[160:163]
    ds_read_b64_tr_b16 v[128:129], v111 offset:20544
    ds_read_b64_tr_b16 v[130:131], v111 offset:23104
    v_mfma_f32_16x16x32_bf16 v[164:167], v[144:147], v[64:67], v[164:167]
    ds_read_b64_tr_b16 v[132:133], v111 offset:20576
    ds_read_b64_tr_b16 v[134:135], v111 offset:23136
    v_mfma_f32_16x16x32_bf16 v[168:171], v[148:151], v[64:67], v[168:171]
    ds_read_b64_tr_b16 v[136:137], v111 offset:20608
    ds_read_b64_tr_b16 v[138:139], v111 offset:23168
    v_mfma_f32_16x16x32_bf16 v[172:175], v[152:155], v[64:67], v[172:175]
    v_mfma_f32_16x16x32_bf16 v[176:179], v[156:159], v[64:67], v[176:179]
    s_waitcnt lgkmcnt(0)
    s_mov_b32 s40, 0
L_sp4:
    ds_read_b32 v4, v8 offset:32
    s_add_u32 s40, s40, 1
    s_waitcnt lgkmcnt(0)
    v_readfirstlane_b32 s39, v4
    s_cmp_ge_u32 s40, 1048576
    s_cbranch_scc1 L_sp4_ok
    s_cmp_ge_u32 s39, 3
    s_cbranch_scc0 L_sp4
L_sp4_ok:
    ds_read_b64_tr_b16 v[140:141], v111 offset:25600
    ds_read_b64_tr_b16 v[142:143], v111 offset:28160
    ds_read_b64_tr_b16 v[144:145], v111 offset:25632
    ds_read_b64_tr_b16 v[146:147], v111 offset:28192
    s_waitcnt lgkmcnt(4)
    v_mfma_f32_16x16x32_bf16 v[160:163], v[120:123], v[68:71], v[160:163]
    ds_read_b64_tr_b16 v[148:149], v111 offset:25664
    ds_read_b64_tr_b16 v[150:151], v111 offset:28224
    v_mfma_f32_16x16x32_bf16 v[164:167], v[124:127], v[68:71], v[164:167]
    ds_read_b64_tr_b16 v[152:153], v111 offset:25696
    ds_read_b64_tr_b16 v[154:155], v111 offset:28256
    v_mfma_f32_16x16x32_bf16 v[168:171], v[128:131], v[68:71], v[168:171]
    ds_read_b64_tr_b16 v[156:157], v111 offset:25728
    ds_read_b64_tr_b16 v[158:159], v111 offset:28288
    v_mfma_f32_16x16x32_bf16 v[172:175], v[132:135], v[68:71], v[172:175]
    v_mfma_f32_16x16x32_bf16 v[176:179], v[136:139], v[68:71], v[176:179]
    ds_read_b64_tr_b16 v[120:121], v111 offset:30720
    ds_read_b64_tr_b16 v[122:123], v111 offset:33280
    ds_read_b64_tr_b16 v[124:125], v111 offset:30752
    ds_read_b64_tr_b16 v[126:127], v111 offset:33312
    s_waitcnt lgkmcnt(4)
    v_mfma_f32_16x16x32_bf16 v[160:163], v[140:143], v[72:75], v[160:163]
    ds_read_b64_tr_b16 v[128:129], v111 offset:30784
    ds_read_b64_tr_b16 v[130:131], v111 offset:33344
    v_mfma_f32_16x16x32_bf16 v[164:167], v[144:147], v[72:75], v[164:167]
    ds_read_b64_tr_b16 v[132:133], v111 offset:30816
    ds_read_b64_tr_b16 v[134:135], v111 offset:33376
    v_mfma_f32_16x16x32_bf16 v[168:171], v[148:151], v[72:75], v[168:171]
    ds_read_b64_tr_b16 v[136:137], v111 offset:30848
    ds_read_b64_tr_b16 v[138:139], v111 offset:33408
    v_mfma_f32_16x16x32_bf16 v[172:175], v[152:155], v[72:75], v[172:175]
    v_mfma_f32_16x16x32_bf16 v[176:179], v[156:159], v[72:75], v[176:179]
    ds_read_b64_tr_b16 v[140:141], v111 offset:35840
    ds_read_b64_tr_b16 v[142:143], v111 offset:38400
    ds_read_b64_tr_b16 v[144:145], v111 offset:35872
    ds_read_b64_tr_b16 v[146:147], v111 offset:38432
    s_waitcnt lgkmcnt(4)
    v_mfma_f32_16x16x32_bf16 v[160:163], v[120:123], v[76:79], v[160:163]
    ds_read_b64_tr_b16 v[148:149], v111 offset:35904
    ds_read_b64_tr_b16 v[150:151], v111 offset:38464
    v_mfma_f32_16x16x32_bf16 v[164:167], v[124:127], v[76:79], v[164:167]
    ds_read_b64_tr_b16 v[152:153], v111 offset:35936
    ds_read_b64_tr_b16 v[154:155], v111 offset:38496
    v_mfma_f32_16x16x32_bf16 v[168:171], v[128:131], v[76:79], v[168:171]
    ds_read_b64_tr_b16 v[156:157], v111 offset:35968
    ds_read_b64_tr_b16 v[158:159], v111 offset:38528
    v_mfma_f32_16x16x32_bf16 v[172:175], v[132:135], v[76:79], v[172:175]
    v_mfma_f32_16x16x32_bf16 v[176:179], v[136:139], v[76:79], v[176:179]
    ds_read_b64_tr_b16 v[120:121], v111 offset:40960
    ds_read_b64_tr_b16 v[122:123], v111 offset:43520
    ds_read_b64_tr_b16 v[124:125], v111 offset:40992
    ds_read_b64_tr_b16 v[126:127], v111 offset:43552
    s_waitcnt lgkmcnt(4)
    v_mfma_f32_16x16x32_bf16 v[160:163], v[140:143], v[80:83], v[160:163]
    ds_read_b64_tr_b16 v[128:129], v111 offset:41024
    ds_read_b64_tr_b16 v[130:131], v111 offset:43584
    v_mfma_f32_16x16x32_bf16 v[164:167], v[144:147], v[80:83], v[164:167]
    ds_read_b64_tr_b16 v[132:133], v111 offset:41056
    ds_read_b64_tr_b16 v[134:135], v111 offset:43616
    v_mfma_f32_16x16x32_bf16 v[168:171], v[148:151], v[80:83], v[168:171]
    ds_read_b64_tr_b16 v[136:137], v111 offset:41088
    ds_read_b64_tr_b16 v[138:139], v111 offset:43648
    v_mfma_f32_16x16x32_bf16 v[172:175], v[152:155], v[80:83], v[172:175]
    v_mfma_f32_16x16x32_bf16 v[176:179], v[156:159], v[80:83], v[176:179]
    ds_read_b64_tr_b16 v[140:141], v111 offset:46080
    ds_read_b64_tr_b16 v[142:143], v111 offset:48640
    ds_read_b64_tr_b16 v[144:145], v111 offset:46112
    ds_read_b64_tr_b16 v[146:147], v111 offset:48672
    s_waitcnt lgkmcnt(4)
    v_mfma_f32_16x16x32_bf16 v[160:163], v[120:123], v[84:87], v[160:163]
    ds_read_b64_tr_b16 v[148:149], v111 offset:46144
    ds_read_b64_tr_b16 v[150:151], v111 offset:48704
    v_mfma_f32_16x16x32_bf16 v[164:167], v[124:127], v[84:87], v[164:167]
    ds_read_b64_tr_b16 v[152:153], v111 offset:46176
    ds_read_b64_tr_b16 v[154:155], v111 offset:48736
    v_mfma_f32_16x16x32_bf16 v[168:171], v[128:131], v[84:87], v[168:171]
    ds_read_b64_tr_b16 v[156:157], v111 offset:46208
    ds_read_b64_tr_b16 v[158:159], v111 offset:48768
    v_mfma_f32_16x16x32_bf16 v[172:175], v[132:135], v[84:87], v[172:175]
    v_mfma_f32_16x16x32_bf16 v[176:179], v[136:139], v[84:87], v[176:179]
    s_waitcnt lgkmcnt(0)
    v_mfma_f32_16x16x32_bf16 v[160:163], v[140:143], v[88:91], v[160:163]
    v_mfma_f32_16x16x32_bf16 v[164:167], v[144:147], v[88:91], v[164:167]
    v_mfma_f32_16x16x32_bf16 v[168:171], v[148:151], v[88:91], v[168:171]
    v_mfma_f32_16x16x32_bf16 v[172:175], v[152:155], v[88:91], v[172:175]
    v_mfma_f32_16x16x32_bf16 v[176:179], v[156:159], v[88:91], v[176:179]
    s_mov_b32 s43, 0x3ea52b5c
    s_nop 6
    v_mul_f32 v160, s43, v160
    v_mul_f32 v161, s43, v161
    v_mul_f32 v162, s43, v162
    v_mul_f32 v163, s43, v163
    v_cvt_pk_bf16_f32 v120, v160, v161
    v_cvt_pk_bf16_f32 v121, v162, v163
    ds_write_b64 v112, v[120:121]
    v_mul_f32 v164, s43, v164
    v_mul_f32 v165, s43, v165
    v_mul_f32 v166, s43, v166
    v_mul_f32 v167, s43, v167
    v_cvt_pk_bf16_f32 v122, v164, v165
    v_cvt_pk_bf16_f32 v123, v166, v167
    ds_write_b64 v113, v[122:123]
    v_mul_f32 v168, s43, v168
    v_mul_f32 v169, s43, v169
    v_mul_f32 v170, s43, v170
    v_mul_f32 v171, s43, v171
    v_cvt_pk_bf16_f32 v124, v168, v169
    v_cvt_pk_bf16_f32 v125, v170, v171
    ds_write_b64 v114, v[124:125]
    v_mul_f32 v172, s43, v172
    v_mul_f32 v173, s43, v173
    v_mul_f32 v174, s43, v174
    v_mul_f32 v175, s43, v175
    v_cvt_pk_bf16_f32 v126, v172, v173
    v_cvt_pk_bf16_f32 v127, v174, v175
    ds_write_b64 v115, v[126:127]
    v_mul_f32 v176, s43, v176
    v_mul_f32 v177, s43, v177
    v_mul_f32 v178, s43, v178
    v_mul_f32 v179, s43, v179
    v_cvt_pk_bf16_f32 v128, v176, v177
    v_cvt_pk_bf16_f32 v129, v178, v179
    ds_write_b64 v116, v[128:129]
    s_waitcnt lgkmcnt(0)
    s_barrier
L_attn:
    v_lshlrev_b32 v131, 4, v0
    v_mov_b32 v132, 161792
    v_mov_b32 v133, 1
    v_lshlrev_b32 v134, 3, v0
    s_mov_b32 s21, 20480
    buffer_load_dwordx2 v[140:141], v134, s[4:7], s21 offen sc1
    s_mul_i32 s29, s12, 47
    s_lshr_b32 s29, s29, 9
    s_mul_i32 s29, s29, 11
    s_sub_u32 s29, s12, s29
    s_lshl_b32 s20, s10, 10
    s_add_u32 s21, s20, 65536
    s_add_u32 m0, s20, 0
    s_nop 0
    buffer_load_dwordx4 v131, s[4:7], s21 offen sc1 lds
    s_add_u32 m0, s20, 4096
    s_add_u32 s21, s21, 4096
    buffer_load_dwordx4 v131, s[4:7], s21 offen sc1 lds
    s_add_u32 m0, s20, 8192
    s_add_u32 s21, s21, 4096
    buffer_load_dwordx4 v131, s[4:7], s21 offen sc1 lds
    s_add_u32 m0, s20, 12288
    s_add_u32 s21, s21, 4096
    buffer_load_dwordx4 v131, s[4:7], s21 offen sc1 lds
    s_add_u32 m0, s20, 16384
    s_add_u32 s21, s21, 4096
    buffer_load_dwordx4 v131, s[4:7], s21 offen sc1 lds
    s_add_u32 m0, s20, 20480
    s_add_u32 s21, s21, 4096
    buffer_load_dwordx4 v131, s[4:7], s21 offen sc1 lds
    s_add_u32 m0, s20, 24576
    s_add_u32 s21, s21, 4096
    buffer_load_dwordx4 v131, s[4:7], s21 offen sc1 lds
    s_add_u32 m0, s20, 28672
    s_add_u32 s21, s21, 4096
    buffer_load_dwordx4 v131, s[4:7], s21 offen sc1 lds
    s_add_u32 m0, s20, 32768
    s_add_u32 s21, s21, 4096
    buffer_load_dwordx4 v131, s[4:7], s21 offen sc1 lds
    s_add_u32 m0, s20, 36864
    s_add_u32 s21, s21, 4096
    buffer_load_dwordx4 v131, s[4:7], s21 offen sc1 lds
    s_cmp_ge_u32 s10, 2
    s_cbranch_scc1 L_dm7
    s_add_u32 m0, s20, 40960
    s_add_u32 s21, s21, 4096
    buffer_load_dwordx4 v131, s[4:7], s21 offen sc1 lds
L_dm7:
    s_lshl_b32 s20, s10, 10
    s_add_u32 s21, s20, 108544
    s_add_u32 m0, s20, 43008
    s_nop 0
    buffer_load_dwordx4 v131, s[4:7], s21 offen sc1 lds
    s_add_u32 m0, s20, 47104
    s_add_u32 s21, s21, 4096
    buffer_load_dwordx4 v131, s[4:7], s21 offen sc1 lds
    s_add_u32 m0, s20, 51200
    s_add_u32 s21, s21, 4096
    buffer_load_dwordx4 v131, s[4:7], s21 offen sc1 lds
    s_add_u32 m0, s20, 55296
    s_add_u32 s21, s21, 4096
    buffer_load_dwordx4 v131, s[4:7], s21 offen sc1 lds
    s_add_u32 m0, s20, 59392
    s_add_u32 s21, s21, 4096
    buffer_load_dwordx4 v131, s[4:7], s21 offen sc1 lds
    s_add_u32 m0, s20, 63488
    s_add_u32 s21, s21, 4096
    buffer_load_dwordx4 v131, s[4:7], s21 offen sc1 lds
    s_add_u32 m0, s20, 67584
    s_add_u32 s21, s21, 4096
    buffer_load_dwordx4 v131, s[4:7], s21 offen sc1 lds
    s_add_u32 m0, s20, 71680
    s_add_u32 s21, s21, 4096
    buffer_load_dwordx4 v131, s[4:7], s21 offen sc1 lds
    s_add_u32 m0, s20, 75776
    s_add_u32 s21, s21, 4096
    buffer_load_dwordx4 v131, s[4:7], s21 offen sc1 lds
    s_add_u32 m0, s20, 79872
    s_add_u32 s21, s21, 4096
    buffer_load_dwordx4 v131, s[4:7], s21 offen sc1 lds
    s_cmp_ge_u32 s10, 2
    s_cbranch_scc1 L_dm8
    s_add_u32 m0, s20, 83968
    s_add_u32 s21, s21, 4096
    buffer_load_dwordx4 v131, s[4:7], s21 offen sc1 lds
L_dm8:
    s_mov_b32 s31, 4294902784
    s_mov_b32 s32, 21504
    s_mul_i32 s20, s10, 2560
    s_add_u32 s20, s20, 151552
    v_add_u32 v134, s20, v131
    v_and_b32 v135, 31, v0
    v_lshlrev_b32 v136, 3, v135
    v_add_u32 v136, s20, v136
    ds_read_b128 v[4:7], v134
    ds_read_b128 v[8:11], v134 offset:1280
    ds_read_b64 v[12:13], v136 offset:1024
    ds_read_b64 v[14:15], v136 offset:2304
    v_mov_b32 v128, v131
    v_and_b32 v134, 31, v0
    v_lshlrev_b32 v129, 3, v134
    v_add_u32 v129, 1024, v129
    v_mov_b32 v135, 1440
    v_cmp_le_u32 vcc, 32, v0
    s_nop 1
    v_cndmask_b32 v129, v129, v135, vcc
    v_lshrrev_b32 v135, 3, v134
    v_and_b32 v136, 3, v134
    v_lshl_add_u32 v135, v135, 2, v136
    v_bfe_u32 v136, v134, 2, 1
    v_mul_u32_u24 v136, 10, v136
    v_add_u32 v136, v136, v135
    v_add_u32 v137, 7, v136
    v_cmp_gt_u32 vcc, 4, v136
    s_nop 1
    v_cndmask_b32 v137, v137, v136, vcc
    v_subrev_u32 v138, 10, v136
    v_cmp_le_u32 vcc, 14, v136
    s_nop 1
    v_cndmask_b32 v137, v137, v138, vcc
    v_mov_b32 v138, 10
    v_cmp_eq_u32 vcc, 10, v135
    s_nop 1
    v_cndmask_b32 v137, v137, v138, vcc
    v_mov_b32 v138, 21
    v_cmp_lt_u32 vcc, 10, v135
    s_nop 1
    v_cndmask_b32 v137, v137, v138, vcc
    v_lshrrev_b32 v136, 5, v0
    v_mul_u32_u24 v136, 352, v136
    v_lshl_add_u32 v130, v137, 4, v136
    v_add_u32 v130, 1280, v130
    v_mov_b32 v132, 161792
    v_mov_b32 v133, 1
    v_mov_b32 v96, 0
    v_mov_b32 v112, 0
    v_mov_b32 v97, 0
    v_mov_b32 v113, 0
    v_mov_b32 v98, 0
    v_mov_b32 v114, 0
    v_mov_b32 v99, 0
    v_mov_b32 v115, 0
    v_mov_b32 v100, 0
    v_mov_b32 v116, 0
    v_mov_b32 v101, 0
    v_mov_b32 v117, 0
    v_mov_b32 v102, 0
    v_mov_b32 v118, 0
    v_mov_b32 v103, 0
    v_mov_b32 v119, 0
    v_mov_b32 v104, 0
    v_mov_b32 v120, 0
    v_mov_b32 v105, 0
    v_mov_b32 v121, 0
    v_mov_b32 v106, 0
    v_mov_b32 v122, 0
    v_mov_b32 v107, 0
    v_mov_b32 v123, 0
    v_mov_b32 v108, 0
    v_mov_b32 v124, 0
    v_mov_b32 v109, 0
    v_mov_b32 v125, 0
    v_mov_b32 v110, 0
    v_mov_b32 v126, 0
    v_mov_b32 v111, 0
    v_mov_b32 v127, 0
    v_mov_b32 v88, 0
    v_mov_b32 v40, 0
    v_mov_b32 v89, 0
    v_mov_b32 v41, 0
    v_mov_b32 v90, 0
    v_mov_b32 v42, 0
    v_mov_b32 v91, 0
    v_mov_b32 v43, 0
    v_mov_b32 v92, 0
    v_mov_b32 v44, 0
    v_mov_b32 v93, 0
    v_mov_b32 v45, 0
    v_mov_b32 v94, 0
    v_mov_b32 v46, 0
    v_mov_b32 v95, 0
    v_mov_b32 v47, 0
    v_and_b32 v134, 31, v0
    v_lshrrev_b32 v135, 5, v0
    s_mul_i32 s20, s10, 20
    v_mul_u32_u24 v135, 10, v135
    v_add_u32 v135, s20, v135
    v_add_u32 v136, 0, v135
    v_lshrrev_b32 v137, 3, v136
    v_lshlrev_b32 v137, 9, v137
    v_lshl_add_u32 v137, v134, 4, v137
    v_and_b32 v136, 7, v136
    v_lshl_add_u32 v148, v136, 1, v137
    v_add_u32 v148, 151552, v148
    v_add_u32 v136, 2, v135
    v_lshrrev_b32 v137, 3, v136
    v_lshlrev_b32 v137, 9, v137
    v_lshl_add_u32 v137, v134, 4, v137
    v_and_b32 v136, 7, v136
    v_lshl_add_u32 v149, v136, 1, v137
    v_add_u32 v149, 151552, v149
    v_add_u32 v136, 4, v135
    v_lshrrev_b32 v137, 3, v136
    v_lshlrev_b32 v137, 9, v137
    v_lshl_add_u32 v137, v134, 4, v137
    v_and_b32 v136, 7, v136
    v_lshl_add_u32 v150, v136, 1, v137
    v_add_u32 v150, 151552, v150
    v_add_u32 v136, 6, v135
    v_lshrrev_b32 v137, 3, v136
    v_lshlrev_b32 v137, 9, v137
    v_lshl_add_u32 v137, v134, 4, v137
    v_and_b32 v136, 7, v136
    v_lshl_add_u32 v151, v136, 1, v137
    v_add_u32 v151, 151552, v151
    v_add_u32 v136, 8, v135
    v_lshrrev_b32 v137, 3, v136
    v_lshlrev_b32 v137, 9, v137
    v_lshl_add_u32 v137, v134, 4, v137
    v_and_b32 v136, 7, v136
    v_lshl_add_u32 v152, v136, 1, v137
    v_add_u32 v152, 151552, v152
    s_waitcnt lgkmcnt(0)
    s_mov_b32 exec_lo, 0
    v_mov_b32 v12, 0
    v_mov_b32 v14, 0
    v_mov_b32 v13, 0
    v_mov_b32 v15, 0
    s_mov_b32 exec_lo, -1
    v_mov_b32 v132, 161792
    v_mov_b32 v133, 1
    s_waitcnt vmcnt(20)
    v_max_f32 v140, v140, v141
    s_nop 1
    v_max_f32_dpp v140, v140, v140 row_ror:8 row_mask:0xf bank_mask:0xf
    s_nop 1
    v_max_f32_dpp v140, v140, v140 row_ror:4 row_mask:0xf bank_mask:0xf
    s_nop 1
    v_max_f32_dpp v140, v140, v140 row_ror:2 row_mask:0xf bank_mask:0xf
    s_nop 1
    v_max_f32_dpp v140, v140, v140 row_ror:1 row_mask:0xf bank_mask:0xf
    v_mov_b32 v134, v140
    s_nop 1
    v_permlane16_swap_b32 v140, v134
    s_nop 0
    v_max_f32 v140, v140, v134
    v_mov_b32 v134, v140
    s_nop 1
    v_permlane32_swap_b32 v140, v134
    s_nop 0
    v_max_f32 v140, v140, v134
    v_mov_b32 v135, 0
    v_dot2c_f32_bf16 v135, v4, v4
    v_dot2c_f32_bf16 v135, v5, v5
    v_dot2c_f32_bf16 v135, v6, v6
    v_dot2c_f32_bf16 v135, v7, v7
    v_dot2c_f32_bf16 v135, v12, v12
    v_dot2c_f32_bf16 v135, v13, v13
    s_nop 2
    v_mov_b32 v134, v135
    s_nop 1
    v_permlane32_swap_b32 v135, v134
    s_nop 0
    v_add_f32 v135, v135, v134
    v_mov_b32 v136, 0
    v_dot2c_f32_bf16 v136, v8, v8
    v_dot2c_f32_bf16 v136, v9, v9
    v_dot2c_f32_bf16 v136, v10, v10
    v_dot2c_f32_bf16 v136, v11, v11
    v_dot2c_f32_bf16 v136, v14, v14
    v_dot2c_f32_bf16 v136, v15, v15
    s_nop 2
    v_mov_b32 v134, v136
    s_nop 1
    v_permlane32_swap_b32 v136, v134
    s_nop 0
    v_add_f32 v136, v136, v134
    v_max_f32 v135, v135, v136
    v_mul_f32 v135, v135, v140
    v_mov_b32 v136, 0x45fd2000
    v_cmp_nle_f32 vcc, v135, v136
    s_nop 4
    s_cbranch_vccnz L_att_slow
L_att_fast:
    s_waitcnt vmcnt(10)
    s_mov_b64 exec, 1
    ds_add_u32 v132, v133 offset:24
    s_mov_b64 exec, -1
    s_mov_b32 s28, 0
L_sp9:
    ds_read_b32 v138, v132 offset:24
    s_add_u32 s28, s28, 1
    s_waitcnt lgkmcnt(0)
    v_readfirstlane_b32 s22, v138
    s_cmp_ge_u32 s28, 1048576
    s_cbranch_scc1 L_sp9_ok
    s_cmp_ge_u32 s22, 4
    s_cbranch_scc0 L_sp9
L_sp9_ok:
    ds_read_b128 v[16:19], v128 offset:0
    ds_read_b64 v[20:21], v129 offset:0
    s_waitcnt lgkmcnt(0)
    v_mfma_f32_32x32x16_bf16 v[48:63], v[16:19], v[4:7], 0
    v_mfma_f32_32x32x8_bf16 v[48:63], v[20:21], v[12:13], v[48:63]
    s_mov_b32 s23, 0
    s_mov_b32 s24, 4
    v_lshlrev_b32 v153, 2, v0
    v_add_u32 v153, 161856, v153
    v_cmp_eq_u32 vcc, 0, v0
    s_nop 1
    v_cndmask_b32 v153, v153, v132, vcc
    s_nop 6
.p2align 6
L_att_loop:
    s_bitcmp1_b32 0x88, s23
    s_cselect_b32 s27, s31, s32
    ds_read_b128 v[24:27], v128 offset:2688
    ds_read_b64 v[28:29], v129 offset:2688
    ds_read_b128 v[32:35], v130 offset:0
    ds_read_b128 v[36:39], v130 offset:704
    v_mfma_f32_32x32x16_bf16 v[64:79], v[16:19], v[8:11], 0
    v_exp_f32 v48, v48
    v_exp_f32 v49, v49
    v_exp_f32 v50, v50
    v_cvt_pk_bf16_f32 v80, v48, v49
    v_mfma_f32_32x32x8_bf16 v[64:79], v[20:21], v[14:15], v[64:79]
    v_exp_f32 v51, v51
    v_exp_f32 v52, v52
    v_cvt_pk_bf16_f32 v81, v50, v51
    v_exp_f32 v53, v53
    v_exp_f32 v54, v54
    v_mfma_f32_32x32x16_bf16 v[112:127], v[40:43], v[88:91], v[112:127]
    v_cvt_pk_bf16_f32 v82, v52, v53
    v_exp_f32 v55, v55
    v_exp_f32 v56, v56
    v_cvt_pk_bf16_f32 v83, v54, v55
    v_mfma_f32_32x32x16_bf16 v[112:127], v[44:47], v[92:95], v[112:127]
    v_exp_f32 v57, v57
    v_exp_f32 v58, v58
    v_cvt_pk_bf16_f32 v84, v56, v57
    v_exp_f32 v59, v59
    v_exp_f32 v60, v60
    v_cvt_pk_bf16_f32 v85, v58, v59
    v_exp_f32 v61, v61
    v_exp_f32 v62, v62
    v_cvt_pk_bf16_f32 v86, v60, v61
    v_exp_f32 v63, v63
    s_waitcnt lgkmcnt(0)
    v_cvt_pk_bf16_f32 v87, v62, v63
    v_mfma_f32_32x32x16_bf16 v[48:63], v[24:27], v[4:7], 0
    v_exp_f32 v64, v64
    v_exp_f32 v65, v65
    v_exp_f32 v66, v66
    v_cvt_pk_bf16_f32 v88, v64, v65
    v_mfma_f32_32x32x8_bf16 v[48:63], v[28:29], v[12:13], v[48:63]
    v_exp_f32 v67, v67
    v_exp_f32 v68, v68
    v_cvt_pk_bf16_f32 v89, v66, v67
    v_exp_f32 v69, v69
    v_exp_f32 v70, v70
    v_mfma_f32_32x32x16_bf16 v[96:111], v[32:35], v[80:83], v[96:111]
    v_cvt_pk_bf16_f32 v90, v68, v69
    v_exp_f32 v71, v71
    v_exp_f32 v72, v72
    v_cvt_pk_bf16_f32 v91, v70, v71
    v_mfma_f32_32x32x16_bf16 v[96:111], v[36:39], v[84:87], v[96:111]
    v_exp_f32 v73, v73
    v_exp_f32 v74, v74
    v_cvt_pk_bf16_f32 v92, v72, v73
    v_exp_f32 v75, v75
    v_exp_f32 v76, v76
    v_cvt_pk_bf16_f32 v93, v74, v75
    v_exp_f32 v77, v77
    v_exp_f32 v78, v78
    v_cvt_pk_bf16_f32 v94, v76, v77
    v_exp_f32 v79, v79
    ds_read_b128 v[16:19], v128 offset:5376
    ds_read_b64 v[20:21], v129 offset:5376
    ds_read_b128 v[40:43], v130 offset:2688
    ds_read_b128 v[44:47], v130 offset:3392
    v_cvt_pk_bf16_f32 v95, v78, v79
    v_mfma_f32_32x32x16_bf16 v[64:79], v[24:27], v[8:11], 0
    v_exp_f32 v48, v48
    v_exp_f32 v49, v49
    v_exp_f32 v50, v50
    v_cvt_pk_bf16_f32 v80, v48, v49
    v_mfma_f32_32x32x8_bf16 v[64:79], v[28:29], v[14:15], v[64:79]
    v_exp_f32 v51, v51
    v_exp_f32 v52, v52
    v_cvt_pk_bf16_f32 v81, v50, v51
    v_exp_f32 v53, v53
    v_exp_f32 v54, v54
    v_mfma_f32_32x32x16_bf16 v[112:127], v[32:35], v[88:91], v[112:127]
    v_cvt_pk_bf16_f32 v82, v52, v53
    v_exp_f32 v55, v55
    v_exp_f32 v56, v56
    v_cvt_pk_bf16_f32 v83, v54, v55
    v_mfma_f32_32x32x16_bf16 v[112:127], v[36:39], v[92:95], v[112:127]
    v_exp_f32 v57, v57
    v_exp_f32 v58, v58
    v_cvt_pk_bf16_f32 v84, v56, v57
    v_exp_f32 v59, v59
    v_exp_f32 v60, v60
    v_cvt_pk_bf16_f32 v85, v58, v59
    v_exp_f32 v61, v61
    v_exp_f32 v62, v62
    v_cvt_pk_bf16_f32 v86, v60, v61
    v_exp_f32 v63, v63
    s_waitcnt lgkmcnt(0)
    v_cvt_pk_bf16_f32 v87, v62, v63
    v_mfma_f32_32x32x16_bf16 v[48:63], v[16:19], v[4:7], 0
    v_exp_f32 v64, v64
    v_exp_f32 v65, v65
    v_exp_f32 v66, v66
    v_cvt_pk_bf16_f32 v88, v64, v65
    v_mfma_f32_32x32x8_bf16 v[48:63], v[20:21], v[12:13], v[48:63]
    v_exp_f32 v67, v67
    v_exp_f32 v68, v68
    v_cvt_pk_bf16_f32 v89, v66, v67
    v_exp_f32 v69, v69
    v_exp_f32 v70, v70
    v_mfma_f32_32x32x16_bf16 v[96:111], v[40:43], v[80:83], v[96:111]
    v_cvt_pk_bf16_f32 v90, v68, v69
    v_exp_f32 v71, v71
    v_exp_f32 v72, v72
    v_cvt_pk_bf16_f32 v91, v70, v71
    v_mfma_f32_32x32x16_bf16 v[96:111], v[44:47], v[84:87], v[96:111]
    v_exp_f32 v73, v73
    v_exp_f32 v74, v74
    v_cvt_pk_bf16_f32 v92, v72, v73
    v_exp_f32 v75, v75
    v_exp_f32 v76, v76
    v_cvt_pk_bf16_f32 v93, v74, v75
    v_exp_f32 v77, v77
    v_exp_f32 v78, v78
    v_cvt_pk_bf16_f32 v94, v76, v77
    v_exp_f32 v79, v79
    ds_read_b128 v[24:27], v128 offset:8064
    ds_read_b64 v[28:29], v129 offset:8064
    ds_read_b128 v[32:35], v130 offset:5376
    ds_read_b128 v[36:39], v130 offset:6080
    v_cvt_pk_bf16_f32 v95, v78, v79
    v_mfma_f32_32x32x16_bf16 v[64:79], v[16:19], v[8:11], 0
    v_exp_f32 v48, v48
    v_exp_f32 v49, v49
    v_exp_f32 v50, v50
    v_cvt_pk_bf16_f32 v80, v48, v49
    v_mfma_f32_32x32x8_bf16 v[64:79], v[20:21], v[14:15], v[64:79]
    v_exp_f32 v51, v51
    v_exp_f32 v52, v52
    v_cvt_pk_bf16_f32 v81, v50, v51
    v_exp_f32 v53, v53
    v_exp_f32 v54, v54
    v_mfma_f32_32x32x16_bf16 v[112:127], v[40:43], v[88:91], v[112:127]
    v_cvt_pk_bf16_f32 v82, v52, v53
    v_exp_f32 v55, v55
    v_exp_f32 v56, v56
    v_cvt_pk_bf16_f32 v83, v54, v55
    v_mfma_f32_32x32x16_bf16 v[112:127], v[44:47], v[92:95], v[112:127]
    v_exp_f32 v57, v57
    v_exp_f32 v58, v58
    v_cvt_pk_bf16_f32 v84, v56, v57
    v_exp_f32 v59, v59
    v_exp_f32 v60, v60
    v_cvt_pk_bf16_f32 v85, v58, v59
    v_exp_f32 v61, v61
    v_exp_f32 v62, v62
    v_cvt_pk_bf16_f32 v86, v60, v61
    v_exp_f32 v63, v63
    s_waitcnt lgkmcnt(0)
    v_cvt_pk_bf16_f32 v87, v62, v63
    v_mfma_f32_32x32x16_bf16 v[48:63], v[24:27], v[4:7], 0
    v_exp_f32 v64, v64
    v_exp_f32 v65, v65
    v_exp_f32 v66, v66
    v_cvt_pk_bf16_f32 v88, v64, v65
    v_mfma_f32_32x32x8_bf16 v[48:63], v[28:29], v[12:13], v[48:63]
    v_exp_f32 v67, v67
    v_exp_f32 v68, v68
    v_cvt_pk_bf16_f32 v89, v66, v67
    v_exp_f32 v69, v69
    v_exp_f32 v70, v70
    v_mfma_f32_32x32x16_bf16 v[96:111], v[32:35], v[80:83], v[96:111]
    v_cvt_pk_bf16_f32 v90, v68, v69
    v_exp_f32 v71, v71
    v_exp_f32 v72, v72
    v_cvt_pk_bf16_f32 v91, v70, v71
    v_mfma_f32_32x32x16_bf16 v[96:111], v[36:39], v[84:87], v[96:111]
    v_exp_f32 v73, v73
    v_exp_f32 v74, v74
    v_cvt_pk_bf16_f32 v92, v72, v73
    v_exp_f32 v75, v75
    v_exp_f32 v76, v76
    v_cvt_pk_bf16_f32 v93, v74, v75
    v_exp_f32 v77, v77
    v_exp_f32 v78, v78
    v_cvt_pk_bf16_f32 v94, v76, v77
    v_exp_f32 v79, v79
    ds_read_b128 v[16:19], v128 offset:10752
    ds_read_b64 v[20:21], v129 offset:10752
    ds_read_b128 v[40:43], v130 offset:8064
    ds_read_b128 v[44:47], v130 offset:8768
    v_cvt_pk_bf16_f32 v95, v78, v79
    v_mfma_f32_32x32x16_bf16 v[64:79], v[24:27], v[8:11], 0
    v_exp_f32 v48, v48
    v_exp_f32 v49, v49
    v_exp_f32 v50, v50
    v_cvt_pk_bf16_f32 v80, v48, v49
    v_mfma_f32_32x32x8_bf16 v[64:79], v[28:29], v[14:15], v[64:79]
    v_exp_f32 v51, v51
    v_exp_f32 v52, v52
    v_cvt_pk_bf16_f32 v81, v50, v51
    v_exp_f32 v53, v53
    v_exp_f32 v54, v54
    v_mfma_f32_32x32x16_bf16 v[112:127], v[32:35], v[88:91], v[112:127]
    v_cvt_pk_bf16_f32 v82, v52, v53
    v_exp_f32 v55, v55
    v_exp_f32 v56, v56
    v_cvt_pk_bf16_f32 v83, v54, v55
    v_mfma_f32_32x32x16_bf16 v[112:127], v[36:39], v[92:95], v[112:127]
    v_exp_f32 v57, v57
    v_exp_f32 v58, v58
    v_cvt_pk_bf16_f32 v84, v56, v57
    v_exp_f32 v59, v59
    v_exp_f32 v60, v60
    v_cvt_pk_bf16_f32 v85, v58, v59
    v_exp_f32 v61, v61
    v_exp_f32 v62, v62
    v_cvt_pk_bf16_f32 v86, v60, v61
    v_exp_f32 v63, v63
    s_waitcnt lgkmcnt(0)
    v_cvt_pk_bf16_f32 v87, v62, v63
    v_mfma_f32_32x32x16_bf16 v[48:63], v[16:19], v[4:7], 0
    v_exp_f32 v64, v64
    v_exp_f32 v65, v65
    v_exp_f32 v66, v66
    v_cvt_pk_bf16_f32 v88, v64, v65
    v_mfma_f32_32x32x8_bf16 v[48:63], v[20:21], v[12:13], v[48:63]
    v_exp_f32 v67, v67
    v_exp_f32 v68, v68
    v_cvt_pk_bf16_f32 v89, v66, v67
    v_exp_f32 v69, v69
    v_exp_f32 v70, v70
    v_mfma_f32_32x32x16_bf16 v[96:111], v[40:43], v[80:83], v[96:111]
    v_cvt_pk_bf16_f32 v90, v68, v69
    v_exp_f32 v71, v71
    v_exp_f32 v72, v72
    v_cvt_pk_bf16_f32 v91, v70, v71
    v_mfma_f32_32x32x16_bf16 v[96:111], v[44:47], v[84:87], v[96:111]
    v_exp_f32 v73, v73
    v_exp_f32 v74, v74
    v_cvt_pk_bf16_f32 v92, v72, v73
    v_exp_f32 v75, v75
    v_exp_f32 v76, v76
    v_cvt_pk_bf16_f32 v93, v74, v75
    v_exp_f32 v77, v77
    v_exp_f32 v78, v78
    v_cvt_pk_bf16_f32 v94, v76, v77
    v_exp_f32 v79, v79
    s_waitcnt vmcnt(0)
    ds_add_u32 v153, v133 offset:0
    ds_read_b128 v[24:27], v128 offset:13440
    ds_read_b64 v[28:29], v129 offset:13440
    ds_read_b128 v[32:35], v130 offset:10752
    ds_read_b128 v[36:39], v130 offset:11456
    v_cvt_pk_bf16_f32 v95, v78, v79
    v_mfma_f32_32x32x16_bf16 v[64:79], v[16:19], v[8:11], 0
    v_exp_f32 v48, v48
    v_exp_f32 v49, v49
    v_exp_f32 v50, v50
    v_cvt_pk_bf16_f32 v80, v48, v49
    v_mfma_f32_32x32x8_bf16 v[64:79], v[20:21], v[14:15], v[64:79]
    v_exp_f32 v51, v51
    v_exp_f32 v52, v52
    v_cvt_pk_bf16_f32 v81, v50, v51
    v_exp_f32 v53, v53
    v_exp_f32 v54, v54
    v_mfma_f32_32x32x16_bf16 v[112:127], v[40:43], v[88:91], v[112:127]
    v_cvt_pk_bf16_f32 v82, v52, v53
    v_exp_f32 v55, v55
    v_exp_f32 v56, v56
    v_cvt_pk_bf16_f32 v83, v54, v55
    v_mfma_f32_32x32x16_bf16 v[112:127], v[44:47], v[92:95], v[112:127]
    v_exp_f32 v57, v57
    v_exp_f32 v58, v58
    v_cvt_pk_bf16_f32 v84, v56, v57
    v_exp_f32 v59, v59
    v_exp_f32 v60, v60
    v_cvt_pk_bf16_f32 v85, v58, v59
    v_exp_f32 v61, v61
    v_exp_f32 v62, v62
    v_cvt_pk_bf16_f32 v86, v60, v61
    v_exp_f32 v63, v63
    s_waitcnt lgkmcnt(0)
    v_cvt_pk_bf16_f32 v87, v62, v63
    v_mfma_f32_32x32x16_bf16 v[48:63], v[24:27], v[4:7], 0
    v_exp_f32 v64, v64
    v_exp_f32 v65, v65
    v_exp_f32 v66, v66
    v_cvt_pk_bf16_f32 v88, v64, v65
    v_mfma_f32_32x32x8_bf16 v[48:63], v[28:29], v[12:13], v[48:63]
    v_exp_f32 v67, v67
    v_exp_f32 v68, v68
    v_cvt_pk_bf16_f32 v89, v66, v67
    v_exp_f32 v69, v69
    v_exp_f32 v70, v70
    v_mfma_f32_32x32x16_bf16 v[96:111], v[32:35], v[80:83], v[96:111]
    v_cvt_pk_bf16_f32 v90, v68, v69
    v_exp_f32 v71, v71
    v_exp_f32 v72, v72
    v_cvt_pk_bf16_f32 v91, v70, v71
    v_mfma_f32_32x32x16_bf16 v[96:111], v[36:39], v[84:87], v[96:111]
    v_exp_f32 v73, v73
    v_exp_f32 v74, v74
    v_cvt_pk_bf16_f32 v92, v72, v73
    v_exp_f32 v75, v75
    v_exp_f32 v76, v76
    v_cvt_pk_bf16_f32 v93, v74, v75
    v_exp_f32 v77, v77
    v_exp_f32 v78, v78
    v_cvt_pk_bf16_f32 v94, v76, v77
    v_exp_f32 v79, v79
    s_bitcmp1_b32 20, s23
    s_cbranch_scc1 L_att_dma
L_att_dma_ret:
    ds_read_b128 v[16:19], v128 offset:16128
    ds_read_b64 v[20:21], v129 offset:16128
    ds_read_b128 v[40:43], v130 offset:13440
    ds_read_b128 v[44:47], v130 offset:14144
    v_cvt_pk_bf16_f32 v95, v78, v79
    v_mfma_f32_32x32x16_bf16 v[64:79], v[24:27], v[8:11], 0
    v_exp_f32 v48, v48
    v_exp_f32 v49, v49
    v_exp_f32 v50, v50
    v_cvt_pk_bf16_f32 v80, v48, v49
    v_mfma_f32_32x32x8_bf16 v[64:79], v[28:29], v[14:15], v[64:79]
    v_exp_f32 v51, v51
    v_exp_f32 v52, v52
    v_cvt_pk_bf16_f32 v81, v50, v51
    v_exp_f32 v53, v53
    v_exp_f32 v54, v54
    v_mfma_f32_32x32x16_bf16 v[112:127], v[32:35], v[88:91], v[112:127]
    v_cvt_pk_bf16_f32 v82, v52, v53
    v_exp_f32 v55, v55
    v_exp_f32 v56, v56
    v_cvt_pk_bf16_f32 v83, v54, v55
    v_mfma_f32_32x32x16_bf16 v[112:127], v[36:39], v[92:95], v[112:127]
    v_exp_f32 v57, v57
    v_exp_f32 v58, v58
    v_cvt_pk_bf16_f32 v84, v56, v57
    v_exp_f32 v59, v59
    v_exp_f32 v60, v60
    v_cvt_pk_bf16_f32 v85, v58, v59
    v_exp_f32 v61, v61
    v_exp_f32 v62, v62
    v_cvt_pk_bf16_f32 v86, v60, v61
    v_exp_f32 v63, v63
    s_waitcnt lgkmcnt(0)
    v_cvt_pk_bf16_f32 v87, v62, v63
    v_mfma_f32_32x32x16_bf16 v[48:63], v[16:19], v[4:7], 0
    v_exp_f32 v64, v64
    v_exp_f32 v65, v65
    v_exp_f32 v66, v66
    v_cvt_pk_bf16_f32 v88, v64, v65
    v_mfma_f32_32x32x8_bf16 v[48:63], v[20:21], v[12:13], v[48:63]
    v_exp_f32 v67, v67
    v_exp_f32 v68, v68
    v_cvt_pk_bf16_f32 v89, v66, v67
    v_exp_f32 v69, v69
    v_exp_f32 v70, v70
    v_mfma_f32_32x32x16_bf16 v[96:111], v[40:43], v[80:83], v[96:111]
    v_cvt_pk_bf16_f32 v90, v68, v69
    v_exp_f32 v71, v71
    v_exp_f32 v72, v72
    v_cvt_pk_bf16_f32 v91, v70, v71
    v_mfma_f32_32x32x16_bf16 v[96:111], v[44:47], v[84:87], v[96:111]
    v_exp_f32 v73, v73
    v_exp_f32 v74, v74
    v_cvt_pk_bf16_f32 v92, v72, v73
    v_exp_f32 v75, v75
    v_exp_f32 v76, v76
    v_cvt_pk_bf16_f32 v93, v74, v75
    v_exp_f32 v77, v77
    v_exp_f32 v78, v78
    v_cvt_pk_bf16_f32 v94, v76, v77
    v_exp_f32 v79, v79
    ds_read_b128 v[24:27], v128 offset:18816
    ds_read_b64 v[28:29], v129 offset:18816
    ds_read_b128 v[32:35], v130 offset:16128
    ds_read_b128 v[36:39], v130 offset:16832
    ds_read_b32 v138, v132 offset:0
    v_cvt_pk_bf16_f32 v95, v78, v79
    v_mfma_f32_32x32x16_bf16 v[64:79], v[16:19], v[8:11], 0
    v_exp_f32 v48, v48
    v_exp_f32 v49, v49
    v_exp_f32 v50, v50
    v_cvt_pk_bf16_f32 v80, v48, v49
    v_mfma_f32_32x32x8_bf16 v[64:79], v[20:21], v[14:15], v[64:79]
    v_exp_f32 v51, v51
    v_exp_f32 v52, v52
    v_cvt_pk_bf16_f32 v81, v50, v51
    v_exp_f32 v53, v53
    v_exp_f32 v54, v54
    v_mfma_f32_32x32x16_bf16 v[112:127], v[40:43], v[88:91], v[112:127]
    v_cvt_pk_bf16_f32 v82, v52, v53
    v_exp_f32 v55, v55
    v_exp_f32 v56, v56
    v_cvt_pk_bf16_f32 v83, v54, v55
    v_mfma_f32_32x32x16_bf16 v[112:127], v[44:47], v[92:95], v[112:127]
    v_exp_f32 v57, v57
    v_exp_f32 v58, v58
    v_cvt_pk_bf16_f32 v84, v56, v57
    v_exp_f32 v59, v59
    v_exp_f32 v60, v60
    v_cvt_pk_bf16_f32 v85, v58, v59
    v_exp_f32 v61, v61
    v_exp_f32 v62, v62
    v_cvt_pk_bf16_f32 v86, v60, v61
    v_exp_f32 v63, v63
    s_waitcnt lgkmcnt(0)
    v_cvt_pk_bf16_f32 v87, v62, v63
    v_mfma_f32_32x32x16_bf16 v[48:63], v[24:27], v[4:7], 0
    v_exp_f32 v64, v64
    v_exp_f32 v65, v65
    v_exp_f32 v66, v66
    v_cvt_pk_bf16_f32 v88, v64, v65
    v_mfma_f32_32x32x8_bf16 v[48:63], v[28:29], v[12:13], v[48:63]
    v_exp_f32 v67, v67
    v_exp_f32 v68, v68
    v_cvt_pk_bf16_f32 v89, v66, v67
    v_exp_f32 v69, v69
    v_exp_f32 v70, v70
    v_mfma_f32_32x32x16_bf16 v[96:111], v[32:35], v[80:83], v[96:111]
    v_cvt_pk_bf16_f32 v90, v68, v69
    v_exp_f32 v71, v71
    v_exp_f32 v72, v72
    v_cvt_pk_bf16_f32 v91, v70, v71
    v_mfma_f32_32x32x16_bf16 v[96:111], v[36:39], v[84:87], v[96:111]
    v_exp_f32 v73, v73
    v_exp_f32 v74, v74
    v_cvt_pk_bf16_f32 v92, v72, v73
    v_exp_f32 v75, v75
    v_exp_f32 v76, v76
    v_cvt_pk_bf16_f32 v93, v74, v75
    v_exp_f32 v77, v77
    v_exp_f32 v78, v78
    v_cvt_pk_bf16_f32 v94, v76, v77
    v_exp_f32 v79, v79
    v_readfirstlane_b32 s22, v138
    s_cmp_ge_u32 s22, s24
    s_cbranch_scc0 L_att_rdy
L_att_rdy_ret:
    v_add_u32 v128, s27, v128
    v_add_u32 v129, s27, v129
    ds_read_b128 v[16:19], v128 offset:0
    ds_read_b64 v[20:21], v129 offset:0
    ds_read_b128 v[40:43], v130 offset:18816
    ds_read_b128 v[44:47], v130 offset:19520
    v_add_u32 v130, s27, v130
    v_cvt_pk_bf16_f32 v95, v78, v79
    v_mfma_f32_32x32x16_bf16 v[64:79], v[24:27], v[8:11], 0
    v_exp_f32 v48, v48
    v_exp_f32 v49, v49
    v_exp_f32 v50, v50
    v_cvt_pk_bf16_f32 v80, v48, v49
    v_mfma_f32_32x32x8_bf16 v[64:79], v[28:29], v[14:15], v[64:79]
    v_exp_f32 v51, v51
    v_exp_f32 v52, v52
    v_cvt_pk_bf16_f32 v81, v50, v51
    v_exp_f32 v53, v53
    v_exp_f32 v54, v54
    v_mfma_f32_32x32x16_bf16 v[112:127], v[32:35], v[88:91], v[112:127]
    v_cvt_pk_bf16_f32 v82, v52, v53
    v_exp_f32 v55, v55
    v_exp_f32 v56, v56
    v_cvt_pk_bf16_f32 v83, v54, v55
    v_mfma_f32_32x32x16_bf16 v[112:127], v[36:39], v[92:95], v[112:127]
    v_exp_f32 v57, v57
    v_exp_f32 v58, v58
    v_cvt_pk_bf16_f32 v84, v56, v57
    v_exp_f32 v59, v59
    v_exp_f32 v60, v60
    v_cvt_pk_bf16_f32 v85, v58, v59
    v_exp_f32 v61, v61
    v_exp_f32 v62, v62
    v_cvt_pk_bf16_f32 v86, v60, v61
    v_exp_f32 v63, v63
    s_waitcnt lgkmcnt(0)
    ds_add_u32 v153, v133 offset:4
    v_cvt_pk_bf16_f32 v87, v62, v63
    v_mfma_f32_32x32x16_bf16 v[48:63], v[16:19], v[4:7], 0
    v_exp_f32 v64, v64
    v_exp_f32 v65, v65
    v_exp_f32 v66, v66
    v_cvt_pk_bf16_f32 v88, v64, v65
    v_mfma_f32_32x32x8_bf16 v[48:63], v[20:21], v[12:13], v[48:63]
    v_exp_f32 v67, v67
    v_exp_f32 v68, v68
    v_cvt_pk_bf16_f32 v89, v66, v67
    v_exp_f32 v69, v69
    v_exp_f32 v70, v70
    v_mfma_f32_32x32x16_bf16 v[96:111], v[40:43], v[80:83], v[96:111]
    v_cvt_pk_bf16_f32 v90, v68, v69
    v_exp_f32 v71, v71
    v_exp_f32 v72, v72
    v_cvt_pk_bf16_f32 v91, v70, v71
    v_mfma_f32_32x32x16_bf16 v[96:111], v[44:47], v[84:87], v[96:111]
    v_exp_f32 v73, v73
    v_exp_f32 v74, v74
    v_cvt_pk_bf16_f32 v92, v72, v73
    v_exp_f32 v75, v75
    v_exp_f32 v76, v76
    v_cvt_pk_bf16_f32 v93, v74, v75
    v_exp_f32 v77, v77
    v_exp_f32 v78, v78
    v_cvt_pk_bf16_f32 v94, v76, v77
    v_exp_f32 v79, v79
    s_add_u32 s23, s23, 1
    v_cvt_pk_bf16_f32 v95, v78, v79
    s_add_u32 s24, s24, 4
    s_cmp_lt_u32 s23, 8
    s_cbranch_scc1 L_att_loop
    s_branch L_att_fin
L_att_dma:
    s_lshl_b32 s26, s23, 2
    s_mov_b32 s28, 0
L_sp10:
    ds_read_b32 v134, v132 offset:4
    s_add_u32 s28, s28, 1
    s_waitcnt lgkmcnt(0)
    v_readfirstlane_b32 s22, v134
    s_cmp_ge_u32 s28, 1048576
    s_cbranch_scc1 L_sp10_ok
    s_cmp_ge_u32 s22, s26
    s_cbranch_scc0 L_sp10
L_sp10_ok:
    s_lshr_b32 s20, s23, 1
    s_add_u32 s20, s20, 1
    s_mul_i32 s26, s20, 43008
    s_add_u32 s26, s26, 65536
    s_and_b32 s20, s20, 1
    s_mul_i32 s22, s20, 43008
    s_lshl_b32 s20, s10, 10
    s_add_u32 s26, s26, s20
    s_add_u32 s22, s22, s20
    s_add_u32 m0, s22, 0
    s_nop 0
    buffer_load_dwordx4 v131, s[4:7], s26 offen sc1 lds
    s_add_u32 m0, s22, 4096
    s_add_u32 s26, s26, 4096
    buffer_load_dwordx4 v131, s[4:7], s26 offen sc1 lds
    s_add_u32 m0, s22, 8192
    s_add_u32 s26, s26, 4096
    buffer_load_dwordx4 v131, s[4:7], s26 offen sc1 lds
    s_add_u32 m0, s22, 12288
    s_add_u32 s26, s26, 4096
    buffer_load_dwordx4 v131, s[4:7], s26 offen sc1 lds
    s_add_u32 m0, s22, 16384
    s_add_u32 s26, s26, 4096
    buffer_load_dwordx4 v131, s[4:7], s26 offen sc1 lds
    s_add_u32 m0, s22, 20480
    s_add_u32 s26, s26, 4096
    buffer_load_dwordx4 v131, s[4:7], s26 offen sc1 lds
    s_add_u32 m0, s22, 24576
    s_add_u32 s26, s26, 4096
    buffer_load_dwordx4 v131, s[4:7], s26 offen sc1 lds
    s_add_u32 m0, s22, 28672
    s_add_u32 s26, s26, 4096
    buffer_load_dwordx4 v131, s[4:7], s26 offen sc1 lds
    s_add_u32 m0, s22, 32768
    s_add_u32 s26, s26, 4096
    buffer_load_dwordx4 v131, s[4:7], s26 offen sc1 lds
    s_add_u32 m0, s22, 36864
    s_add_u32 s26, s26, 4096
    buffer_load_dwordx4 v131, s[4:7], s26 offen sc1 lds
    s_cmp_ge_u32 s10, 2
    s_cbranch_scc1 L_att_dma_x
    s_add_u32 m0, s22, 40960
    s_add_u32 s26, s26, 4096
    buffer_load_dwordx4 v131, s[4:7], s26 offen sc1 lds
L_att_dma_x:
    s_branch L_att_dma_ret
L_att_rdy:
    s_mov_b32 s28, 0
L_sp11:
    ds_read_b32 v134, v132 offset:0
    s_add_u32 s28, s28, 1
    s_waitcnt lgkmcnt(0)
    v_readfirstlane_b32 s22, v134
    s_cmp_ge_u32 s28, 1048576
    s_cbranch_scc1 L_sp11_ok
    s_cmp_ge_u32 s22, s24
    s_cbranch_scc0 L_sp11
L_sp11_ok:
    s_branch L_att_rdy_ret
L_att_fin:
    s_nop 0
    v_mfma_f32_32x32x16_bf16 v[112:127], v[40:43], v[88:91], v[112:127]
    v_mfma_f32_32x32x16_bf16 v[112:127], v[44:47], v[92:95], v[112:127]
    s_nop 7
    s_nop 3
    v_rcp_f32 v136, v106
    s_nop 0
    v_mul_f32 v96, v96, v136
    v_mul_f32 v97, v97, v136
    v_mul_f32 v98, v98, v136
    v_mul_f32 v99, v99, v136
    v_mul_f32 v100, v100, v136
    v_mul_f32 v101, v101, v136
    v_mul_f32 v102, v102, v136
    v_mul_f32 v103, v103, v136
    v_mul_f32 v104, v104, v136
    v_mul_f32 v105, v105, v136
    v_cvt_pk_bf16_f32 v96, v96, v97
    v_cvt_pk_bf16_f32 v97, v98, v99
    v_cvt_pk_bf16_f32 v98, v100, v101
    v_cvt_pk_bf16_f32 v99, v102, v103
    v_cvt_pk_bf16_f32 v100, v104, v105
    ds_write_b32 v148, v96 offset:0
    ds_write_b32 v149, v97 offset:0
    ds_write_b32 v150, v98 offset:0
    ds_write_b32 v151, v99 offset:0
    ds_write_b32 v152, v100 offset:0
    v_rcp_f32 v136, v122
    s_nop 0
    v_mul_f32 v112, v112, v136
    v_mul_f32 v113, v113, v136
    v_mul_f32 v114, v114, v136
    v_mul_f32 v115, v115, v136
    v_mul_f32 v116, v116, v136
    v_mul_f32 v117, v117, v136
    v_mul_f32 v118, v118, v136
    v_mul_f32 v119, v119, v136
    v_mul_f32 v120, v120, v136
    v_mul_f32 v121, v121, v136
    v_cvt_pk_bf16_f32 v112, v112, v113
    v_cvt_pk_bf16_f32 v113, v114, v115
    v_cvt_pk_bf16_f32 v114, v116, v117
    v_cvt_pk_bf16_f32 v115, v118, v119
    v_cvt_pk_bf16_f32 v116, v120, v121
    ds_write_b32 v148, v112 offset:5120
    ds_write_b32 v149, v113 offset:5120
    ds_write_b32 v150, v114 offset:5120
    ds_write_b32 v151, v115 offset:5120
    ds_write_b32 v152, v116 offset:5120
    s_waitcnt lgkmcnt(0)
    s_mov_b64 exec, 1
    ds_add_u32 v132, v133 offset:8
    s_mov_b64 exec, -1
    s_mov_b32 s28, 0
L_sp12:
    ds_read_b32 v138, v132 offset:8
    s_add_u32 s28, s28, 1
    s_waitcnt lgkmcnt(0)
    v_readfirstlane_b32 s22, v138
    s_cmp_ge_u32 s28, 1048576
    s_cbranch_scc1 L_sp12_ok
    s_cmp_ge_u32 s22, 4
    s_cbranch_scc0 L_sp12
L_sp12_ok:
    s_mul_i32 s25, s8, 80
    s_mul_i32 s20, s9, 5
    s_add_u32 s25, s25, s20
    s_lshl_b32 s25, s25, 10
    s_add_u32 s25, s25, 5767168
    s_lshl_b32 s21, s10, 10
    v_add_u32 v134, s21, v131
    v_add_u32 v134, 151552, v134
    ds_read_b128 v[48:51], v134 offset:0
    ds_read_b128 v[52:55], v134 offset:4096
    ds_read_b128 v[56:59], v134 offset:8192
    s_add_u32 s20, s10, 0
    s_cmp_ge_u32 s20, 5
    s_cselect_b32 s24, 35840, 0
    s_lshl_b32 s20, s20, 10
    s_add_u32 s20, s20, s24
    s_add_u32 s21, s20, s25
    s_add_u32 s20, s10, 4
    s_cmp_ge_u32 s20, 5
    s_cselect_b32 s24, 35840, 0
    s_lshl_b32 s20, s20, 10
    s_add_u32 s20, s20, s24
    s_add_u32 s22, s20, s25
    s_add_u32 s20, s10, 8
    s_cmp_ge_u32 s20, 5
    s_cselect_b32 s24, 35840, 0
    s_lshl_b32 s20, s20, 10
    s_add_u32 s20, s20, s24
    s_add_u32 s26, s20, s25
    s_waitcnt lgkmcnt(0)
    buffer_store_dwordx4 v[48:51], v131, s[4:7], s21 offen sc1
    buffer_store_dwordx4 v[52:55], v131, s[4:7], s22 offen sc1
    s_cmp_ge_u32 s10, 2
    s_cbranch_scc1 L_att_st
    buffer_store_dwordx4 v[56:59], v131, s[4:7], s26 offen sc1
L_att_st:
    s_lshl_b32 s20, s8, 3
    s_add_u32 s20, s20, s9
    s_lshl_b32 s20, s20, 2
    s_add_u32 s20, s20, s10
    s_lshl_b32 s20, s20, 7
    s_add_u32 s20, s20, 8585216
    s_waitcnt vmcnt(0)
    v_mov_b32 v134, s11
    v_mov_b32 v135, 0
    s_mov_b64 exec, 1
    buffer_store_dword v134, v135, s[4:7], s20 offen sc1
    s_mov_b64 exec, -1
    s_or_b32 s20, s2, s10
    s_cmp_lg_u32 s20, 0
    s_cbranch_scc1 L_att_end
    s_mov_b32 s20, 0
    v_mov_b32 v134, s11
    v_mov_b32 v135, 0
    s_mov_b64 exec, 1
    buffer_store_dword v134, v135, s[4:7], s20 offen sc1
    s_mov_b64 exec, -1
L_att_end:
    s_endpgm
L_att_slow:
    v_mov_b32 v135, 0xff800000
    v_mov_b32 v136, 0xff800000
    s_mov_b32 s22, 65536
    s_mov_b32 s23, 64
L_att_smax:
    buffer_load_dwordx4 v[16:19], v128, s[4:7], s22 offen sc1
    buffer_load_dwordx2 v[20:21], v129, s[4:7], s22 offen sc1
    s_waitcnt vmcnt(0)
    v_mfma_f32_32x32x16_bf16 v[48:63], v[16:19], v[4:7], 0
    v_mfma_f32_32x32x16_bf16 v[64:79], v[16:19], v[8:11], 0
    v_mfma_f32_32x32x8_bf16 v[48:63], v[20:21], v[12:13], v[48:63]
    v_mfma_f32_32x32x8_bf16 v[64:79], v[20:21], v[14:15], v[64:79]
    s_nop 15
    v_max3_f32 v135, v48, v49, v135
    v_max3_f32 v136, v64, v65, v136
    v_max3_f32 v135, v50, v51, v135
    v_max3_f32 v136, v66, v67, v136
    v_max3_f32 v135, v52, v53, v135
    v_max3_f32 v136, v68, v69, v136
    v_max3_f32 v135, v54, v55, v135
    v_max3_f32 v136, v70, v71, v136
    v_max3_f32 v135, v56, v57, v135
    v_max3_f32 v136, v72, v73, v136
    v_max3_f32 v135, v58, v59, v135
    v_max3_f32 v136, v74, v75, v136
    v_max3_f32 v135, v60, v61, v135
    v_max3_f32 v136, v76, v77, v136
    v_max3_f32 v135, v62, v63, v135
    v_max3_f32 v136, v78, v79, v136
    s_add_u32 s22, s22, 2688
    s_sub_u32 s23, s23, 1
    s_cmp_lg_u32 s23, 0
    s_cbranch_scc1 L_att_smax
    v_mov_b32 v134, v135
    s_nop 1
    v_permlane32_swap_b32 v135, v134
    s_nop 0
    v_max_f32 v135, v135, v134
    v_xor_b32 v135, 0x80000000, v135
    v_and_b32 v137, 0xffff0000, v135
    v_sub_f32 v135, v135, v137
    v_and_b32 v138, 0xffff0000, v135
    v_sub_f32 v135, v135, v138
    v_lshrrev_b32 v137, 16, v137
    v_or_b32 v137, v137, v138
    v_lshrrev_b32 v135, 16, v135
    s_mov_b32 exec_lo, 0
    v_mov_b32 v12, v137
    v_mov_b32 v13, v135
    s_mov_b32 exec_lo, -1
    v_mov_b32 v134, v136
    s_nop 1
    v_permlane32_swap_b32 v136, v134
    s_nop 0
    v_max_f32 v136, v136, v134
    v_xor_b32 v136, 0x80000000, v136
    v_and_b32 v137, 0xffff0000, v136
    v_sub_f32 v136, v136, v137
    v_and_b32 v138, 0xffff0000, v136
    v_sub_f32 v136, v136, v138
    v_lshrrev_b32 v137, 16, v137
    v_or_b32 v137, v137, v138
    v_lshrrev_b32 v136, 16, v136
    s_mov_b32 exec_lo, 0
    v_mov_b32 v14, v137
    v_mov_b32 v15, v136
    s_mov_b32 exec_lo, -1
    s_branch L_att_fast
L_other:
    s_mov_b32 s4, s14
    s_and_b32 s5, s15, 0xffff
    s_mov_b32 s6, 0x10000000
    s_mov_b32 s7, 0x20000
    s_load_dword s11, s[14:15], 0
    s_cmp_lg_u32 s10, 5
    s_cbranch_scc1 L_dma
L_hwait:
    s_mov_b32 s40, 0
L_sp5:
    ds_read_b32 v4, v8 offset:40
    s_add_u32 s40, s40, 1
    s_waitcnt lgkmcnt(0)
    v_readfirstlane_b32 s39, v4
    s_cmp_ge_u32 s40, 1048576
    s_cbranch_scc1 L_sp5_ok
    s_cmp_ge_u32 s39, 4
    s_cbranch_scc0 L_sp5
L_sp5_ok:
    s_branch L_xload
L_h:
    v_mul_f32 v4, v96, v96
    v_mul_f32 v4, v4, v94
    v_add_f32 v4, 0x3727c5ac, v4
    v_rsq_f32 v100, v4
    v_bfe_u32 v4, v0, 2, 2
    v_and_b32 v5, 3, v0
    v_mul_f32 v128, v96, v100
    v_mul_f32 v130, v98, v100
    v_mul_u32_u24 v110, 656, v1
    v_lshl_add_u32 v110, v2, 4, v110
    v_add_u32 v110, 129024, v110
    v_lshrrev_b32 v6, 5, v0
    v_lshl_add_u32 v6, v6, 3, v4
    v_mul_u32_u24 v111, 656, v6
    v_lshl_add_u32 v111, v5, 3, v111
    v_bfe_u32 v6, v0, 4, 1
    v_lshl_add_u32 v111, v6, 5, v111
    v_add_u32 v111, 129024, v111
    s_and_b32 s39, s9, 1
    s_cmp_eq_u32 s39, 1
    s_cbranch_scc1 L_h1
    v_lshlrev_b32 v102, 16, v12
    v_and_b32 v103, 0xffff0000, v12
    v_lshlrev_b32 v104, 16, v13
    v_and_b32 v105, 0xffff0000, v13
    v_lshlrev_b32 v106, 16, v14
    v_and_b32 v107, 0xffff0000, v14
    v_lshlrev_b32 v108, 16, v15
    v_and_b32 v109, 0xffff0000, v15
    v_pk_fma_f32 v[102:103], v[102:103], v[128:129], v[130:131] op_sel_hi:[1,0,0]
    v_pk_fma_f32 v[104:105], v[104:105], v[128:129], v[130:131] op_sel_hi:[1,0,0]
    v_pk_fma_f32 v[106:107], v[106:107], v[128:129], v[130:131] op_sel_hi:[1,0,0]
    v_pk_fma_f32 v[108:109], v[108:109], v[128:129], v[130:131] op_sel_hi:[1,0,0]
    v_cvt_pk_bf16_f32 v12, v102, v103
    v_cvt_pk_bf16_f32 v13, v104, v105
    v_cvt_pk_bf16_f32 v14, v106, v107
    v_cvt_pk_bf16_f32 v15, v108, v109
    ds_write_b128 v110, v[12:15] offset:0
    v_lshlrev_b32 v102, 16, v16
    v_and_b32 v103, 0xffff0000, v16
    v_lshlrev_b32 v104, 16, v17
    v_and_b32 v105, 0xffff0000, v17
    v_lshlrev_b32 v106, 16, v18
    v_and_b32 v107, 0xffff0000, v18
    v_lshlrev_b32 v108, 16, v19
    v_and_b32 v109, 0xffff0000, v19
    v_pk_fma_f32 v[102:103], v[102:103], v[128:129], v[130:131] op_sel_hi:[1,0,0]
    v_pk_fma_f32 v[104:105], v[104:105], v[128:129], v[130:131] op_sel_hi:[1,0,0]
    v_pk_fma_f32 v[106:107], v[106:107], v[128:129], v[130:131] op_sel_hi:[1,0,0]
    v_pk_fma_f32 v[108:109], v[108:109], v[128:129], v[130:131] op_sel_hi:[1,0,0]
    v_cvt_pk_bf16_f32 v16, v102, v103
    v_cvt_pk_bf16_f32 v17, v104, v105
    v_cvt_pk_bf16_f32 v18, v106, v107
    v_cvt_pk_bf16_f32 v19, v108, v109
    ds_write_b128 v110, v[16:19] offset:64
    v_lshlrev_b32 v102, 16, v20
    v_and_b32 v103, 0xffff0000, v20
    v_lshlrev_b32 v104, 16, v21
    v_and_b32 v105, 0xffff0000, v21
    v_lshlrev_b32 v106, 16, v22
    v_and_b32 v107, 0xffff0000, v22
    v_lshlrev_b32 v108, 16, v23
    v_and_b32 v109, 0xffff0000, v23
    v_pk_fma_f32 v[102:103], v[102:103], v[128:129], v[130:131] op_sel_hi:[1,0,0]
    v_pk_fma_f32 v[104:105], v[104:105], v[128:129], v[130:131] op_sel_hi:[1,0,0]
    v_pk_fma_f32 v[106:107], v[106:107], v[128:129], v[130:131] op_sel_hi:[1,0,0]
    v_pk_fma_f32 v[108:109], v[108:109], v[128:129], v[130:131] op_sel_hi:[1,0,0]
    v_cvt_pk_bf16_f32 v20, v102, v103
    v_cvt_pk_bf16_f32 v21, v104, v105
    v_cvt_pk_bf16_f32 v22, v106, v107
    v_cvt_pk_bf16_f32 v23, v108, v109
    ds_write_b128 v110, v[20:23] offset:128
    v_lshlrev_b32 v102, 16, v24
    v_and_b32 v103, 0xffff0000, v24
    v_lshlrev_b32 v104, 16, v25
    v_and_b32 v105, 0xffff0000, v25
    v_lshlrev_b32 v106, 16, v26
    v_and_b32 v107, 0xffff0000, v26
    v_lshlrev_b32 v108, 16, v27
    v_and_b32 v109, 0xffff0000, v27
    v_pk_fma_f32 v[102:103], v[102:103], v[128:129], v[130:131] op_sel_hi:[1,0,0]
    v_pk_fma_f32 v[104:105], v[104:105], v[128:129], v[130:131] op_sel_hi:[1,0,0]
    v_pk_fma_f32 v[106:107], v[106:107], v[128:129], v[130:131] op_sel_hi:[1,0,0]
    v_pk_fma_f32 v[108:109], v[108:109], v[128:129], v[130:131] op_sel_hi:[1,0,0]
    v_cvt_pk_bf16_f32 v24, v102, v103
    v_cvt_pk_bf16_f32 v25, v104, v105
    v_cvt_pk_bf16_f32 v26, v106, v107
    v_cvt_pk_bf16_f32 v27, v108, v109
    ds_write_b128 v110, v[24:27] offset:192
    v_lshlrev_b32 v102, 16, v28
    v_and_b32 v103, 0xffff0000, v28
    v_lshlrev_b32 v104, 16, v29
    v_and_b32 v105, 0xffff0000, v29
    v_lshlrev_b32 v106, 16, v30
    v_and_b32 v107, 0xffff0000, v30
    v_lshlrev_b32 v108, 16, v31
    v_and_b32 v109, 0xffff0000, v31
    v_pk_fma_f32 v[102:103], v[102:103], v[128:129], v[130:131] op_sel_hi:[1,0,0]
    v_pk_fma_f32 v[104:105], v[104:105], v[128:129], v[130:131] op_sel_hi:[1,0,0]
    v_pk_fma_f32 v[106:107], v[106:107], v[128:129], v[130:131] op_sel_hi:[1,0,0]
    v_pk_fma_f32 v[108:109], v[108:109], v[128:129], v[130:131] op_sel_hi:[1,0,0]
    v_cvt_pk_bf16_f32 v28, v102, v103
    v_cvt_pk_bf16_f32 v29, v104, v105
    v_cvt_pk_bf16_f32 v30, v106, v107
    v_cvt_pk_bf16_f32 v31, v108, v109
    ds_write_b128 v110, v[28:31] offset:256
    v_lshlrev_b32 v102, 16, v32
    v_and_b32 v103, 0xffff0000, v32
    v_lshlrev_b32 v104, 16, v33
    v_and_b32 v105, 0xffff0000, v33
    v_lshlrev_b32 v106, 16, v34
    v_and_b32 v107, 0xffff0000, v34
    v_lshlrev_b32 v108, 16, v35
    v_and_b32 v109, 0xffff0000, v35
    v_pk_fma_f32 v[102:103], v[102:103], v[128:129], v[130:131] op_sel_hi:[1,0,0]
    v_pk_fma_f32 v[104:105], v[104:105], v[128:129], v[130:131] op_sel_hi:[1,0,0]
    v_pk_fma_f32 v[106:107], v[106:107], v[128:129], v[130:131] op_sel_hi:[1,0,0]
    v_pk_fma_f32 v[108:109], v[108:109], v[128:129], v[130:131] op_sel_hi:[1,0,0]
    v_cvt_pk_bf16_f32 v32, v102, v103
    v_cvt_pk_bf16_f32 v33, v104, v105
    v_cvt_pk_bf16_f32 v34, v106, v107
    v_cvt_pk_bf16_f32 v35, v108, v109
    ds_write_b128 v110, v[32:35] offset:320
    v_lshlrev_b32 v102, 16, v36
    v_and_b32 v103, 0xffff0000, v36
    v_lshlrev_b32 v104, 16, v37
    v_and_b32 v105, 0xffff0000, v37
    v_lshlrev_b32 v106, 16, v38
    v_and_b32 v107, 0xffff0000, v38
    v_lshlrev_b32 v108, 16, v39
    v_and_b32 v109, 0xffff0000, v39
    v_pk_fma_f32 v[102:103], v[102:103], v[128:129], v[130:131] op_sel_hi:[1,0,0]
    v_pk_fma_f32 v[104:105], v[104:105], v[128:129], v[130:131] op_sel_hi:[1,0,0]
    v_pk_fma_f32 v[106:107], v[106:107], v[128:129], v[130:131] op_sel_hi:[1,0,0]
    v_pk_fma_f32 v[108:109], v[108:109], v[128:129], v[130:131] op_sel_hi:[1,0,0]
    v_cvt_pk_bf16_f32 v36, v102, v103
    v_cvt_pk_bf16_f32 v37, v104, v105
    v_cvt_pk_bf16_f32 v38, v106, v107
    v_cvt_pk_bf16_f32 v39, v108, v109
    ds_write_b128 v110, v[36:39] offset:384
    v_lshlrev_b32 v102, 16, v40
    v_and_b32 v103, 0xffff0000, v40
    v_lshlrev_b32 v104, 16, v41
    v_and_b32 v105, 0xffff0000, v41
    v_lshlrev_b32 v106, 16, v42
    v_and_b32 v107, 0xffff0000, v42
    v_lshlrev_b32 v108, 16, v43
    v_and_b32 v109, 0xffff0000, v43
    v_pk_fma_f32 v[102:103], v[102:103], v[128:129], v[130:131] op_sel_hi:[1,0,0]
    v_pk_fma_f32 v[104:105], v[104:105], v[128:129], v[130:131] op_sel_hi:[1,0,0]
    v_pk_fma_f32 v[106:107], v[106:107], v[128:129], v[130:131] op_sel_hi:[1,0,0]
    v_pk_fma_f32 v[108:109], v[108:109], v[128:129], v[130:131] op_sel_hi:[1,0,0]
    v_cvt_pk_bf16_f32 v40, v102, v103
    v_cvt_pk_bf16_f32 v41, v104, v105
    v_cvt_pk_bf16_f32 v42, v106, v107
    v_cvt_pk_bf16_f32 v43, v108, v109
    ds_write_b128 v110, v[40:43] offset:448
    v_lshlrev_b32 v102, 16, v44
    v_and_b32 v103, 0xffff0000, v44
    v_lshlrev_b32 v104, 16, v45
    v_and_b32 v105, 0xffff0000, v45
    v_lshlrev_b32 v106, 16, v46
    v_and_b32 v107, 0xffff0000, v46
    v_lshlrev_b32 v108, 16, v47
    v_and_b32 v109, 0xffff0000, v47
    v_pk_fma_f32 v[102:103], v[102:103], v[128:129], v[130:131] op_sel_hi:[1,0,0]
    v_pk_fma_f32 v[104:105], v[104:105], v[128:129], v[130:131] op_sel_hi:[1,0,0]
    v_pk_fma_f32 v[106:107], v[106:107], v[128:129], v[130:131] op_sel_hi:[1,0,0]
    v_pk_fma_f32 v[108:109], v[108:109], v[128:129], v[130:131] op_sel_hi:[1,0,0]
    v_cvt_pk_bf16_f32 v44, v102, v103
    v_cvt_pk_bf16_f32 v45, v104, v105
    v_cvt_pk_bf16_f32 v46, v106, v107
    v_cvt_pk_bf16_f32 v47, v108, v109
    ds_write_b128 v110, v[44:47] offset:512
    v_lshlrev_b32 v102, 16, v48
    v_and_b32 v103, 0xffff0000, v48
    v_lshlrev_b32 v104, 16, v49
    v_and_b32 v105, 0xffff0000, v49
    v_lshlrev_b32 v106, 16, v50
    v_and_b32 v107, 0xffff0000, v50
    v_lshlrev_b32 v108, 16, v51
    v_and_b32 v109, 0xffff0000, v51
    v_pk_fma_f32 v[102:103], v[102:103], v[128:129], v[130:131] op_sel_hi:[1,0,0]
    v_pk_fma_f32 v[104:105], v[104:105], v[128:129], v[130:131] op_sel_hi:[1,0,0]
    v_pk_fma_f32 v[106:107], v[106:107], v[128:129], v[130:131] op_sel_hi:[1,0,0]
    v_pk_fma_f32 v[108:109], v[108:109], v[128:129], v[130:131] op_sel_hi:[1,0,0]
    v_cvt_pk_bf16_f32 v48, v102, v103
    v_cvt_pk_bf16_f32 v49, v104, v105
    v_cvt_pk_bf16_f32 v50, v106, v107
    v_cvt_pk_bf16_f32 v51, v108, v109
    ds_write_b128 v110, v[48:51] offset:576
    s_branch L_h2
L_h1:
    v_lshlrev_b32 v102, 16, v52
    v_and_b32 v103, 0xffff0000, v52
    v_lshlrev_b32 v104, 16, v53
    v_and_b32 v105, 0xffff0000, v53
    v_lshlrev_b32 v106, 16, v54
    v_and_b32 v107, 0xffff0000, v54
    v_lshlrev_b32 v108, 16, v55
    v_and_b32 v109, 0xffff0000, v55
    v_pk_fma_f32 v[102:103], v[102:103], v[128:129], v[130:131] op_sel_hi:[1,0,0]
    v_pk_fma_f32 v[104:105], v[104:105], v[128:129], v[130:131] op_sel_hi:[1,0,0]
    v_pk_fma_f32 v[106:107], v[106:107], v[128:129], v[130:131] op_sel_hi:[1,0,0]
    v_pk_fma_f32 v[108:109], v[108:109], v[128:129], v[130:131] op_sel_hi:[1,0,0]
    v_cvt_pk_bf16_f32 v52, v102, v103
    v_cvt_pk_bf16_f32 v53, v104, v105
    v_cvt_pk_bf16_f32 v54, v106, v107
    v_cvt_pk_bf16_f32 v55, v108, v109
    ds_write_b128 v110, v[52:55] offset:0
    v_lshlrev_b32 v102, 16, v56
    v_and_b32 v103, 0xffff0000, v56
    v_lshlrev_b32 v104, 16, v57
    v_and_b32 v105, 0xffff0000, v57
    v_lshlrev_b32 v106, 16, v58
    v_and_b32 v107, 0xffff0000, v58
    v_lshlrev_b32 v108, 16, v59
    v_and_b32 v109, 0xffff0000, v59
    v_pk_fma_f32 v[102:103], v[102:103], v[128:129], v[130:131] op_sel_hi:[1,0,0]
    v_pk_fma_f32 v[104:105], v[104:105], v[128:129], v[130:131] op_sel_hi:[1,0,0]
    v_pk_fma_f32 v[106:107], v[106:107], v[128:129], v[130:131] op_sel_hi:[1,0,0]
    v_pk_fma_f32 v[108:109], v[108:109], v[128:129], v[130:131] op_sel_hi:[1,0,0]
    v_cvt_pk_bf16_f32 v56, v102, v103
    v_cvt_pk_bf16_f32 v57, v104, v105
    v_cvt_pk_bf16_f32 v58, v106, v107
    v_cvt_pk_bf16_f32 v59, v108, v109
    ds_write_b128 v110, v[56:59] offset:64
    v_lshlrev_b32 v102, 16, v60
    v_and_b32 v103, 0xffff0000, v60
    v_lshlrev_b32 v104, 16, v61
    v_and_b32 v105, 0xffff0000, v61
    v_lshlrev_b32 v106, 16, v62
    v_and_b32 v107, 0xffff0000, v62
    v_lshlrev_b32 v108, 16, v63
    v_and_b32 v109, 0xffff0000, v63
    v_pk_fma_f32 v[102:103], v[102:103], v[128:129], v[130:131] op_sel_hi:[1,0,0]
    v_pk_fma_f32 v[104:105], v[104:105], v[128:129], v[130:131] op_sel_hi:[1,0,0]
    v_pk_fma_f32 v[106:107], v[106:107], v[128:129], v[130:131] op_sel_hi:[1,0,0]
    v_pk_fma_f32 v[108:109], v[108:109], v[128:129], v[130:131] op_sel_hi:[1,0,0]
    v_cvt_pk_bf16_f32 v60, v102, v103
    v_cvt_pk_bf16_f32 v61, v104, v105
    v_cvt_pk_bf16_f32 v62, v106, v107
    v_cvt_pk_bf16_f32 v63, v108, v109
    ds_write_b128 v110, v[60:63] offset:128
    v_lshlrev_b32 v102, 16, v64
    v_and_b32 v103, 0xffff0000, v64
    v_lshlrev_b32 v104, 16, v65
    v_and_b32 v105, 0xffff0000, v65
    v_lshlrev_b32 v106, 16, v66
    v_and_b32 v107, 0xffff0000, v66
    v_lshlrev_b32 v108, 16, v67
    v_and_b32 v109, 0xffff0000, v67
    v_pk_fma_f32 v[102:103], v[102:103], v[128:129], v[130:131] op_sel_hi:[1,0,0]
    v_pk_fma_f32 v[104:105], v[104:105], v[128:129], v[130:131] op_sel_hi:[1,0,0]
    v_pk_fma_f32 v[106:107], v[106:107], v[128:129], v[130:131] op_sel_hi:[1,0,0]
    v_pk_fma_f32 v[108:109], v[108:109], v[128:129], v[130:131] op_sel_hi:[1,0,0]
    v_cvt_pk_bf16_f32 v64, v102, v103
    v_cvt_pk_bf16_f32 v65, v104, v105
    v_cvt_pk_bf16_f32 v66, v106, v107
    v_cvt_pk_bf16_f32 v67, v108, v109
    ds_write_b128 v110, v[64:67] offset:192
    v_lshlrev_b32 v102, 16, v68
    v_and_b32 v103, 0xffff0000, v68
    v_lshlrev_b32 v104, 16, v69
    v_and_b32 v105, 0xffff0000, v69
    v_lshlrev_b32 v106, 16, v70
    v_and_b32 v107, 0xffff0000, v70
    v_lshlrev_b32 v108, 16, v71
    v_and_b32 v109, 0xffff0000, v71
    v_pk_fma_f32 v[102:103], v[102:103], v[128:129], v[130:131] op_sel_hi:[1,0,0]
    v_pk_fma_f32 v[104:105], v[104:105], v[128:129], v[130:131] op_sel_hi:[1,0,0]
    v_pk_fma_f32 v[106:107], v[106:107], v[128:129], v[130:131] op_sel_hi:[1,0,0]
    v_pk_fma_f32 v[108:109], v[108:109], v[128:129], v[130:131] op_sel_hi:[1,0,0]
    v_cvt_pk_bf16_f32 v68, v102, v103
    v_cvt_pk_bf16_f32 v69, v104, v105
    v_cvt_pk_bf16_f32 v70, v106, v107
    v_cvt_pk_bf16_f32 v71, v108, v109
    ds_write_b128 v110, v[68:71] offset:256
    v_lshlrev_b32 v102, 16, v72
    v_and_b32 v103, 0xffff0000, v72
    v_lshlrev_b32 v104, 16, v73
    v_and_b32 v105, 0xffff0000, v73
    v_lshlrev_b32 v106, 16, v74
    v_and_b32 v107, 0xffff0000, v74
    v_lshlrev_b32 v108, 16, v75
    v_and_b32 v109, 0xffff0000, v75
    v_pk_fma_f32 v[102:103], v[102:103], v[128:129], v[130:131] op_sel_hi:[1,0,0]
    v_pk_fma_f32 v[104:105], v[104:105], v[128:129], v[130:131] op_sel_hi:[1,0,0]
    v_pk_fma_f32 v[106:107], v[106:107], v[128:129], v[130:131] op_sel_hi:[1,0,0]
    v_pk_fma_f32 v[108:109], v[108:109], v[128:129], v[130:131] op_sel_hi:[1,0,0]
    v_cvt_pk_bf16_f32 v72, v102, v103
    v_cvt_pk_bf16_f32 v73, v104, v105
    v_cvt_pk_bf16_f32 v74, v106, v107
    v_cvt_pk_bf16_f32 v75, v108, v109
    ds_write_b128 v110, v[72:75] offset:320
    v_lshlrev_b32 v102, 16, v76
    v_and_b32 v103, 0xffff0000, v76
    v_lshlrev_b32 v104, 16, v77
    v_and_b32 v105, 0xffff0000, v77
    v_lshlrev_b32 v106, 16, v78
    v_and_b32 v107, 0xffff0000, v78
    v_lshlrev_b32 v108, 16, v79
    v_and_b32 v109, 0xffff0000, v79
    v_pk_fma_f32 v[102:103], v[102:103], v[128:129], v[130:131] op_sel_hi:[1,0,0]
    v_pk_fma_f32 v[104:105], v[104:105], v[128:129], v[130:131] op_sel_hi:[1,0,0]
    v_pk_fma_f32 v[106:107], v[106:107], v[128:129], v[130:131] op_sel_hi:[1,0,0]
    v_pk_fma_f32 v[108:109], v[108:109], v[128:129], v[130:131] op_sel_hi:[1,0,0]
    v_cvt_pk_bf16_f32 v76, v102, v103
    v_cvt_pk_bf16_f32 v77, v104, v105
    v_cvt_pk_bf16_f32 v78, v106, v107
    v_cvt_pk_bf16_f32 v79, v108, v109
    ds_write_b128 v110, v[76:79] offset:384
    v_lshlrev_b32 v102, 16, v80
    v_and_b32 v103, 0xffff0000, v80
    v_lshlrev_b32 v104, 16, v81
    v_and_b32 v105, 0xffff0000, v81
    v_lshlrev_b32 v106, 16, v82
    v_and_b32 v107, 0xffff0000, v82
    v_lshlrev_b32 v108, 16, v83
    v_and_b32 v109, 0xffff0000, v83
    v_pk_fma_f32 v[102:103], v[102:103], v[128:129], v[130:131] op_sel_hi:[1,0,0]
    v_pk_fma_f32 v[104:105], v[104:105], v[128:129], v[130:131] op_sel_hi:[1,0,0]
    v_pk_fma_f32 v[106:107], v[106:107], v[128:129], v[130:131] op_sel_hi:[1,0,0]
    v_pk_fma_f32 v[108:109], v[108:109], v[128:129], v[130:131] op_sel_hi:[1,0,0]
    v_cvt_pk_bf16_f32 v80, v102, v103
    v_cvt_pk_bf16_f32 v81, v104, v105
    v_cvt_pk_bf16_f32 v82, v106, v107
    v_cvt_pk_bf16_f32 v83, v108, v109
    ds_write_b128 v110, v[80:83] offset:448
    v_lshlrev_b32 v102, 16, v84
    v_and_b32 v103, 0xffff0000, v84
    v_lshlrev_b32 v104, 16, v85
    v_and_b32 v105, 0xffff0000, v85
    v_lshlrev_b32 v106, 16, v86
    v_and_b32 v107, 0xffff0000, v86
    v_lshlrev_b32 v108, 16, v87
    v_and_b32 v109, 0xffff0000, v87
    v_pk_fma_f32 v[102:103], v[102:103], v[128:129], v[130:131] op_sel_hi:[1,0,0]
    v_pk_fma_f32 v[104:105], v[104:105], v[128:129], v[130:131] op_sel_hi:[1,0,0]
    v_pk_fma_f32 v[106:107], v[106:107], v[128:129], v[130:131] op_sel_hi:[1,0,0]
    v_pk_fma_f32 v[108:109], v[108:109], v[128:129], v[130:131] op_sel_hi:[1,0,0]
    v_cvt_pk_bf16_f32 v84, v102, v103
    v_cvt_pk_bf16_f32 v85, v104, v105
    v_cvt_pk_bf16_f32 v86, v106, v107
    v_cvt_pk_bf16_f32 v87, v108, v109
    ds_write_b128 v110, v[84:87] offset:512
    v_lshlrev_b32 v102, 16, v88
    v_and_b32 v103, 0xffff0000, v88
    v_lshlrev_b32 v104, 16, v89
    v_and_b32 v105, 0xffff0000, v89
    v_lshlrev_b32 v106, 16, v90
    v_and_b32 v107, 0xffff0000, v90
    v_lshlrev_b32 v108, 16, v91
    v_and_b32 v109, 0xffff0000, v91
    v_pk_fma_f32 v[102:103], v[102:103], v[128:129], v[130:131] op_sel_hi:[1,0,0]
    v_pk_fma_f32 v[104:105], v[104:105], v[128:129], v[130:131] op_sel_hi:[1,0,0]
    v_pk_fma_f32 v[106:107], v[106:107], v[128:129], v[130:131] op_sel_hi:[1,0,0]
    v_pk_fma_f32 v[108:109], v[108:109], v[128:129], v[130:131] op_sel_hi:[1,0,0]
    v_cvt_pk_bf16_f32 v88, v102, v103
    v_cvt_pk_bf16_f32 v89, v104, v105
    v_cvt_pk_bf16_f32 v90, v106, v107
    v_cvt_pk_bf16_f32 v91, v108, v109
    ds_write_b128 v110, v[88:91] offset:576
L_h2:
    s_mul_i32 s39, s39, 1310720
    s_lshl_b32 s40, s37, 10
    s_add_u32 s39, s39, s40
    s_add_u32 s39, s39, 524288
    s_waitcnt lgkmcnt(0)
    s_mov_b32 s18, s11
    s_xor_b32 s11, s11, 0x5bd1e995
    s_mul_i32 s11, s11, 0x9e3779b1
    s_add_u32 s11, s11, 0x7f4a7c15
    s_cmp_eq_u32 s11, s18
    s_addc_u32 s11, s11, 0
    ds_read_b64_tr_b16 v[112:113], v111 offset:0
    ds_read_b64_tr_b16 v[114:115], v111 offset:2624
    ds_read_b64_tr_b16 v[116:117], v111 offset:64
    ds_read_b64_tr_b16 v[118:119], v111 offset:2688
    ds_read_b64_tr_b16 v[120:121], v111 offset:128
    ds_read_b64_tr_b16 v[122:123], v111 offset:2752
    s_waitcnt lgkmcnt(4)
    buffer_store_dwordx4 v[112:115], v7, s[4:7], s39 offen sc1
    s_add_u32 s39, s39, 131072
    ds_read_b64_tr_b16 v[124:125], v111 offset:192
    ds_read_b64_tr_b16 v[126:127], v111 offset:2816
    s_waitcnt lgkmcnt(4)
    buffer_store_dwordx4 v[116:119], v7, s[4:7], s39 offen sc1
    s_add_u32 s39, s39, 131072
    s_nop 1
    ds_read_b64_tr_b16 v[112:113], v111 offset:256
    ds_read_b64_tr_b16 v[114:115], v111 offset:2880
    s_waitcnt lgkmcnt(4)
    buffer_store_dwordx4 v[120:123], v7, s[4:7], s39 offen sc1
    s_add_u32 s39, s39, 131072
    s_nop 1
    ds_read_b64_tr_b16 v[116:117], v111 offset:320
    ds_read_b64_tr_b16 v[118:119], v111 offset:2944
    s_waitcnt lgkmcnt(4)
    buffer_store_dwordx4 v[124:127], v7, s[4:7], s39 offen sc1
    s_add_u32 s39, s39, 131072
    s_nop 1
    ds_read_b64_tr_b16 v[120:121], v111 offset:384
    ds_read_b64_tr_b16 v[122:123], v111 offset:3008
    s_waitcnt lgkmcnt(4)
    buffer_store_dwordx4 v[112:115], v7, s[4:7], s39 offen sc1
    s_add_u32 s39, s39, 131072
    s_nop 1
    ds_read_b64_tr_b16 v[124:125], v111 offset:448
    ds_read_b64_tr_b16 v[126:127], v111 offset:3072
    s_waitcnt lgkmcnt(4)
    buffer_store_dwordx4 v[116:119], v7, s[4:7], s39 offen sc1
    s_add_u32 s39, s39, 131072
    s_nop 1
    ds_read_b64_tr_b16 v[112:113], v111 offset:512
    ds_read_b64_tr_b16 v[114:115], v111 offset:3136
    s_waitcnt lgkmcnt(4)
    buffer_store_dwordx4 v[120:123], v7, s[4:7], s39 offen sc1
    s_add_u32 s39, s39, 131072
    s_nop 1
    ds_read_b64_tr_b16 v[116:117], v111 offset:576
    ds_read_b64_tr_b16 v[118:119], v111 offset:3200
    s_waitcnt lgkmcnt(4)
    buffer_store_dwordx4 v[124:127], v7, s[4:7], s39 offen sc1
    s_add_u32 s39, s39, 131072
    s_waitcnt lgkmcnt(2)
    buffer_store_dwordx4 v[112:115], v7, s[4:7], s39 offen sc1
    s_add_u32 s39, s39, 131072
    s_waitcnt lgkmcnt(0)
    buffer_store_dwordx4 v[116:119], v7, s[4:7], s39 offen sc1
    s_add_u32 s39, s39, 131072
    s_lshl_b32 s39, s8, 3
    s_add_u32 s39, s39, s9
    s_and_b32 s40, s39, 3
    s_lshl_b32 s40, s40, 2
    s_lshr_b32 s39, s39, 2
    s_lshl_b32 s39, s39, 7
    s_add_u32 s39, s39, s40
    s_add_u32 s39, s39, 8421376
    s_waitcnt vmcnt(0)
    v_mov_b32 v4, s11
    v_mov_b32 v5, 0
    s_mov_b64 exec, 1
    buffer_store_dword v4, v5, s[4:7], s39 offen sc1
    s_mov_b64 exec, -1
    s_barrier
    s_setprio 0
    s_branch L_gemm
L_dma:
    s_sub_u32 s44, s10, 5
    s_max_i32 s44, s44, 0
    v_lshlrev_b32 v9, 4, v0
    v_mov_b32 v10, 161792
    v_mov_b32 v11, 1
    v_add_u32 v6, 0, v0
    v_mul_u32_u24 v7, 52429, v6
    v_lshrrev_b32 v7, 19, v7
    v_mul_u32_u24 v8, 10, v7
    v_sub_u32 v6, v6, v8
    v_lshlrev_b32 v1, 4, v6
    v_bfe_u32 v6, v7, 2, 2
    v_lshlrev_b32 v6, 3, v6
    v_lshrrev_b32 v8, 4, v7
    v_lshl_add_u32 v6, v8, 2, v6
    v_and_b32 v8, 3, v7
    v_add_u32 v6, v6, v8
    v_mul_u32_u24 v6, 1280, v6
    v_add_u32 v1, v1, v6
    v_add_u32 v6, 64, v0
    v_mul_u32_u24 v7, 52429, v6
    v_lshrrev_b32 v7, 19, v7
    v_mul_u32_u24 v8, 10, v7
    v_sub_u32 v6, v6, v8
    v_lshlrev_b32 v2, 4, v6
    v_bfe_u32 v6, v7, 2, 2
    v_lshlrev_b32 v6, 3, v6
    v_lshrrev_b32 v8, 4, v7
    v_lshl_add_u32 v6, v8, 2, v6
    v_and_b32 v8, 3, v7
    v_add_u32 v6, v6, v8
    v_mul_u32_u24 v6, 1280, v6
    v_add_u32 v2, v2, v6
    v_add_u32 v6, 128, v0
    v_mul_u32_u24 v7, 52429, v6
    v_lshrrev_b32 v7, 19, v7
    v_mul_u32_u24 v8, 10, v7
    v_sub_u32 v6, v6, v8
    v_lshlrev_b32 v3, 4, v6
    v_bfe_u32 v6, v7, 2, 2
    v_lshlrev_b32 v6, 3, v6
    v_lshrrev_b32 v8, 4, v7
    v_lshl_add_u32 v6, v8, 2, v6
    v_and_b32 v8, 3, v7
    v_add_u32 v6, v6, v8
    v_mul_u32_u24 v6, 1280, v6
    v_add_u32 v3, v3, v6
    v_add_u32 v6, 192, v0
    v_mul_u32_u24 v7, 52429, v6
    v_lshrrev_b32 v7, 19, v7
    v_mul_u32_u24 v8, 10, v7
    v_sub_u32 v6, v6, v8
    v_lshlrev_b32 v4, 4, v6
    v_bfe_u32 v6, v7, 2, 2
    v_lshlrev_b32 v6, 3, v6
    v_lshrrev_b32 v8, 4, v7
    v_lshl_add_u32 v6, v8, 2, v6
    v_and_b32 v8, 3, v7
    v_add_u32 v6, v6, v8
    v_mul_u32_u24 v6, 1280, v6
    v_add_u32 v4, v4, v6
    v_add_u32 v6, 256, v0
    v_mul_u32_u24 v7, 52429, v6
    v_lshrrev_b32 v7, 19, v7
    v_mul_u32_u24 v8, 10, v7
    v_sub_u32 v6, v6, v8
    v_lshlrev_b32 v5, 4, v6
    v_bfe_u32 v6, v7, 2, 2
    v_lshlrev_b32 v6, 3, v6
    v_lshrrev_b32 v8, 4, v7
    v_lshl_add_u32 v6, v8, 2, v6
    v_and_b32 v8, 3, v7
    v_add_u32 v6, v6, v8
    v_mul_u32_u24 v6, 1280, v6
    v_add_u32 v5, v5, v6
    s_mov_b32 s32, s22
    s_and_b32 s33, s23, 0xffff
    s_mov_b32 s34, 0xc8000
    s_mov_b32 s35, 0x20000
    s_mov_b32 s40, s28
    s_and_b32 s41, s29, 0xffff
    s_mov_b32 s42, 0x600000
    s_mov_b32 s43, 0x20000
    s_and_b32 s45, s8, 3
    s_mul_i32 s45, s45, 5
    s_add_u32 s45, s45, s44
    s_mul_i32 s48, s9, 160
    s_mov_b32 s50, s44
    s_cmp_ge_u32 s45, 20
    s_cselect_b32 s46, 20, 0
    s_sub_u32 s45, s45, s46
    s_mul_i32 s47, s45, 40960
    s_add_u32 s47, s47, s48
    s_mul_i32 s46, s50, 5120
    s_add_u32 m0, s46, 0
    s_nop 0
    buffer_load_dwordx4 v1, s[32:35], s47 offen lds
    s_add_u32 m0, s46, 1024
    s_nop 0
    buffer_load_dwordx4 v2, s[32:35], s47 offen lds
    s_add_u32 m0, s46, 2048
    s_nop 0
    buffer_load_dwordx4 v3, s[32:35], s47 offen lds
    s_add_u32 m0, s46, 3072
    s_nop 0
    buffer_load_dwordx4 v4, s[32:35], s47 offen lds
    s_add_u32 m0, s46, 4096
    s_nop 0
    buffer_load_dwordx4 v5, s[32:35], s47 offen lds
    s_add_u32 s45, s45, 3
    s_add_u32 s50, s50, 3
    s_waitcnt vmcnt(5)
    s_mov_b64 exec, 1
    ds_add_u32 v10, v11 offset:28
    s_mov_b64 exec, -1
    s_mov_b32 s49, 4
L_wq:
    s_cmp_ge_u32 s45, 20
    s_cselect_b32 s46, 20, 0
    s_sub_u32 s45, s45, s46
    s_mul_i32 s47, s45, 40960
    s_add_u32 s47, s47, s48
    s_mul_i32 s46, s50, 5120
    s_add_u32 m0, s46, 0
    s_nop 0
    buffer_load_dwordx4 v1, s[32:35], s47 offen lds
    s_add_u32 m0, s46, 1024
    s_nop 0
    buffer_load_dwordx4 v2, s[32:35], s47 offen lds
    s_add_u32 m0, s46, 2048
    s_nop 0
    buffer_load_dwordx4 v3, s[32:35], s47 offen lds
    s_add_u32 m0, s46, 3072
    s_nop 0
    buffer_load_dwordx4 v4, s[32:35], s47 offen lds
    s_add_u32 m0, s46, 4096
    s_nop 0
    buffer_load_dwordx4 v5, s[32:35], s47 offen lds
    s_add_u32 s45, s45, 3
    s_add_u32 s50, s50, 3
    s_sub_u32 s49, s49, 1
    s_cmp_lg_u32 s49, 0
    s_cbranch_scc1 L_wq
    s_waitcnt vmcnt(10)
    s_mov_b64 exec, 1
    ds_add_u32 v10, v11 offset:44
    s_mov_b64 exec, -1
    s_cmp_ge_u32 s45, 20
    s_cselect_b32 s46, 20, 0
    s_sub_u32 s45, s45, s46
    s_mul_i32 s47, s45, 40960
    s_add_u32 s47, s47, s48
    s_mul_i32 s46, s50, 5120
    s_add_u32 m0, s46, 0
    s_nop 0
    buffer_load_dwordx4 v1, s[32:35], s47 offen lds
    s_add_u32 m0, s46, 1024
    s_nop 0
    buffer_load_dwordx4 v2, s[32:35], s47 offen lds
    s_add_u32 m0, s46, 2048
    s_nop 0
    buffer_load_dwordx4 v3, s[32:35], s47 offen lds
    s_add_u32 m0, s46, 3072
    s_nop 0
    buffer_load_dwordx4 v4, s[32:35], s47 offen lds
    s_add_u32 m0, s46, 4096
    s_nop 0
    buffer_load_dwordx4 v5, s[32:35], s47 offen lds
    s_add_u32 s45, s45, 3
    s_add_u32 s50, s50, 3
    s_cmp_eq_u32 s44, 2
    s_cbranch_scc1 L_wq_last
    s_cmp_ge_u32 s45, 20
    s_cselect_b32 s46, 20, 0
    s_sub_u32 s45, s45, s46
    s_mul_i32 s47, s45, 40960
    s_add_u32 s47, s47, s48
    s_mul_i32 s46, s50, 5120
    s_add_u32 m0, s46, 0
    s_nop 0
    buffer_load_dwordx4 v1, s[32:35], s47 offen lds
    s_add_u32 m0, s46, 1024
    s_nop 0
    buffer_load_dwordx4 v2, s[32:35], s47 offen lds
    s_add_u32 m0, s46, 2048
    s_nop 0
    buffer_load_dwordx4 v3, s[32:35], s47 offen lds
    s_add_u32 m0, s46, 3072
    s_nop 0
    buffer_load_dwordx4 v4, s[32:35], s47 offen lds
    s_add_u32 m0, s46, 4096
    s_nop 0
    buffer_load_dwordx4 v5, s[32:35], s47 offen lds
    s_add_u32 s45, s45, 3
    s_add_u32 s50, s50, 3
L_wq_last:
    s_waitcnt vmcnt(5)
    s_mov_b64 exec, 1
    ds_add_u32 v10, v11 offset:48
    s_mov_b64 exec, -1
    s_waitcnt vmcnt(0) lgkmcnt(0)
    s_mov_b32 s18, s11
    s_xor_b32 s11, s11, 0x5bd1e995
    s_mul_i32 s11, s11, 0x9e3779b1
    s_add_u32 s11, s11, 0x7f4a7c15
    s_cmp_eq_u32 s11, s18
    s_addc_u32 s11, s11, 0
    s_mov_b64 exec, 1
    ds_add_u32 v10, v11 offset:32
    s_mov_b64 exec, -1
    s_lshl_b32 s46, s12, 6
    v_add_u32 v6, s46, v0
    v_mul_u32_u24 v6, 3072, v6
    s_and_b32 s47, s13, 3
    s_mul_i32 s47, s47, 768
    s_lshl_b32 s46, s44, 8
    s_add_u32 s47, s47, s46
    buffer_load_dword v255, v6, s[40:43], s47 offen offset:0
    buffer_load_dword v255, v6, s[40:43], s47 offen offset:128
    s_cmp_lg_u32 s10, 4
    s_cbranch_scc1 L_nopoll
    v_lshlrev_b32 v6, 7, v0
    s_mov_b32 s46, 8388608
    s_mov_b32 s47, 0
L_pf6:
    buffer_load_dwordx4 v[12:15], v6, s[4:7], s46 offen sc1
    s_add_u32 s47, s47, 1
    s_waitcnt vmcnt(0)
    v_cmp_ne_u32 vcc, s11, v12
    v_xor_b32 v13, s11, v13
    v_xor_b32 v14, s11, v14
    v_xor_b32 v15, s11, v15
    v_or3_b32 v13, v13, v14, v15
    v_cmp_ne_u32 s[18:19], 0, v13
    s_nop 1
    s_or_b64 vcc, vcc, s[18:19]
    s_cmp_ge_u32 s47, 65536
    s_cbranch_scc1 L_pf6_ok
    s_nop 1
    s_cbranch_vccz L_pf6_ok
    s_sleep 2
    s_branch L_pf6
L_pf6_ok:
L_nopoll:
    s_barrier
    s_branch L_gemm
.p2align 6
L_gemm:
    s_setprio 0
    s_load_dwordx4 s[32:35], s[0:1], 48
    s_load_dwordx4 s[36:39], s[0:1], 64
    s_load_dwordx2 s[40:41], s[0:1], 32
    s_load_dwordx2 s[42:43], s[0:1], 0
    s_load_dwordx2 s[28:29], s[0:1], 80
    s_sub_u32 s46, s10, 4
    s_mul_i32 s47, s46, 16384
    s_add_u32 s47, s47, 86016
    s_mul_i32 s55, s12, 43
    s_lshr_b32 s55, s55, 8
    s_mul_i32 s56, s55, 6
    s_sub_u32 s53, s12, s56
    s_and_b32 s51, s13, 3
    s_mul_i32 s51, s51, 6
    s_add_u32 s51, s51, s53
    s_lshr_b32 s52, s13, 2
    s_mul_i32 s52, s52, 5
    s_add_u32 s52, s52, s55
    v_lshlrev_b32 v3, 4, v0
    v_mov_b32 v1, 161792
    v_mov_b32 v2, 1
    v_lshrrev_b32 v4, 3, v0
    v_bfe_u32 v5, v0, 4, 1
    v_lshlrev_b32 v5, 2, v5
    v_and_b32 v20, 7, v0
    v_xor_b32 v20, v20, v5
    v_lshlrev_b32 v20, 4, v20
    v_mul_u32_u24 v4, 3072, v4
    v_add_u32 v20, v20, v4
    v_bfe_u32 v4, v0, 2, 2
    v_lshrrev_b32 v5, 5, v0
    v_lshlrev_b32 v5, 3, v5
    v_add_u32 v5, v5, v4
    v_lshlrev_b32 v21, 7, v5
    v_bfe_u32 v5, v0, 4, 1
    v_bfe_u32 v6, v0, 1, 1
    v_lshl_add_u32 v5, v5, 1, v6
    v_lshrrev_b32 v4, 1, v4
    v_lshlrev_b32 v4, 2, v4
    v_xor_b32 v5, v5, v4
    v_lshl_add_u32 v21, v5, 4, v21
    v_and_b32 v6, 1, v0
    v_lshl_add_u32 v21, v6, 3, v21
    v_add_u32 v21, s47, v21
    v_xor_b32 v22, 64, v21
    v_add_u32 v23, 131072, v3
    v_add_u32 v12, s47, v3
    s_lshl_b32 s55, s46, 12
    s_add_u32 s55, s55, 86016
    v_add_u32 v25, s55, v3
    s_and_b32 s55, s46, 1
    s_lshl_b32 s55, s55, 1
    s_lshl_b32 s56, s52, 2
    s_add_u32 s55, s55, s56
    v_bfe_u32 v4, v0, 4, 1
    v_add_u32 v4, s55, v4
    v_mul_u32_u24 v5, 52, v4
    v_lshrrev_b32 v5, 8, v5
    v_mul_u32_u24 v6, 5, v5
    v_sub_u32 v4, v4, v6
    v_mul_u32_u24 v5, 3, v5
    v_lshrrev_b32 v6, 1, v4
    v_add_u32 v5, v5, v6
    v_mul_u32_u24 v5, 98304, v5
    v_and_b32 v4, 1, v4
    v_lshlrev_b32 v4, 4, v4
    v_and_b32 v6, 15, v0
    v_add_u32 v4, v4, v6
    v_and_b32 v6, 32, v0
    v_add_u32 v4, v4, v6
    v_lshl_add_u32 v24, v4, 4, v5
    v_mov_b32 v16, 0xc0135761
    v_mov_b32 v18, 1.0
    s_mov_b32 s44, 0xbdd2d3e8
    v_lshrrev_b32 v4, 3, v0
    v_bfe_u32 v5, v0, 4, 1
    v_lshlrev_b32 v5, 2, v5
    v_and_b32 v26, 7, v0
    v_xor_b32 v26, v26, v5
    v_lshlrev_b32 v26, 4, v26
    v_mul_u32_u24 v4, 4096, v4
    v_add_u32 v26, v26, v4
    v_bfe_u32 v4, v0, 2, 2
    v_lshrrev_b32 v5, 5, v0
    v_lshlrev_b32 v5, 2, v5
    v_add_u32 v5, v5, v4
    v_lshlrev_b32 v27, 7, v5
    v_bfe_u32 v5, v0, 4, 1
    v_bfe_u32 v6, v0, 1, 1
    v_lshl_add_u32 v5, v5, 1, v6
    v_lshrrev_b32 v4, 1, v4
    v_lshlrev_b32 v4, 2, v4
    v_xor_b32 v5, v5, v4
    v_lshl_add_u32 v27, v5, 4, v27
    v_and_b32 v6, 1, v0
    v_lshl_add_u32 v27, v6, 3, v27
    v_add_u32 v27, s47, v27
    v_xor_b32 v28, 64, v27
    v_add_u32 v29, 98304, v3
    v_add_u32 v30, 196608, v3
    v_bfe_u32 v4, v0, 4, 1
    v_lshlrev_b32 v4, 30, v4
    v_or_b32 v30, v30, v4
    v_lshlrev_b32 v4, 7, v0
    v_add_u32 v5, 9216, v4
    v_cmp_le_u32 vcc, 24, v0
    s_nop 1
    v_cndmask_b32 v31, v4, v5, vcc
    v_mov_b32 v5, 0
    v_cmp_le_u32 vcc, 48, v0
    s_nop 1
    v_cndmask_b32 v31, v31, v5, vcc
    s_mul_i32 s55, s12, 48
    s_lshl_b32 s56, s46, 4
    s_add_u32 s55, s55, s56
    v_lshrrev_b32 v4, 2, v0
    v_add_u32 v4, s55, v4
    v_lshlrev_b32 v4, 12, v4
    v_and_b32 v5, 3, v0
    v_lshl_add_u32 v32, v5, 7, v4
    v_add_u32 v4, 0, v0
    v_mul_u32_u24 v5, 52429, v4
    v_lshrrev_b32 v5, 19, v5
    v_mul_u32_u24 v6, 10, v5
    v_sub_u32 v6, v4, v6
    v_lshlrev_b32 v46, 4, v6
    v_mul_u32_u24 v5, 1280, v5
    v_add_u32 v46, v46, v5
    v_add_u32 v4, 64, v0
    v_mul_u32_u24 v5, 52429, v4
    v_lshrrev_b32 v5, 19, v5
    v_mul_u32_u24 v6, 10, v5
    v_sub_u32 v6, v4, v6
    v_lshlrev_b32 v47, 4, v6
    v_mul_u32_u24 v5, 1280, v5
    v_add_u32 v47, v47, v5
    v_add_u32 v4, 128, v0
    v_mul_u32_u24 v5, 52429, v4
    v_lshrrev_b32 v5, 19, v5
    v_mul_u32_u24 v6, 10, v5
    v_sub_u32 v6, v4, v6
    v_lshlrev_b32 v48, 4, v6
    v_mul_u32_u24 v5, 1280, v5
    v_add_u32 v48, v48, v5
    v_add_u32 v4, 192, v0
    v_mul_u32_u24 v5, 52429, v4
    v_lshrrev_b32 v5, 19, v5
    v_mul_u32_u24 v6, 10, v5
    v_sub_u32 v6, v4, v6
    v_lshlrev_b32 v49, 4, v6
    v_mul_u32_u24 v5, 1280, v5
    v_add_u32 v49, v49, v5
    v_add_u32 v4, 256, v0
    v_mul_u32_u24 v5, 52429, v4
    v_lshrrev_b32 v5, 19, v5
    v_mul_u32_u24 v6, 10, v5
    v_sub_u32 v6, v4, v6
    v_lshlrev_b32 v50, 4, v6
    v_mul_u32_u24 v5, 1280, v5
    v_add_u32 v50, v50, v5
    v_lshrrev_b32 v4, 5, v0
    v_lshlrev_b32 v4, 3, v4
    v_bfe_u32 v5, v0, 2, 2
    v_add_u32 v4, v4, v5
    v_mul_u32_u24 v51, 160, v4
    v_bfe_u32 v5, v0, 4, 1
    v_lshl_add_u32 v51, v5, 5, v51
    v_and_b32 v5, 3, v0
    v_lshl_add_u32 v51, v5, 3, v51
    v_add_u32 v51, s47, v51
    v_add_u32 v14, 40960, v3
    v_and_b32 v4, 31, v0
    v_mul_u32_u24 v13, 1280, v4
    v_lshrrev_b32 v5, 5, v0
    v_lshl_add_u32 v13, v5, 3, v13
    s_lshl_b32 s54, s8, 1
    s_lshr_b32 s55, s46, 1
    s_add_u32 s54, s54, s55
    s_lshl_b32 s50, s54, 6
    s_mul_i32 s58, s54, 40960
    s_mul_i32 s54, s9, 160
    s_add_u32 s58, s58, s54
    s_and_b32 s55, s46, 1
    s_mul_i32 s55, s55, 80
    s_add_u32 s58, s58, s55
    s_mul_i32 s59, s46, 204800
    s_add_u32 s59, s59, s54
    s_waitcnt lgkmcnt(0)
    s_mov_b32 s20, s42
    s_and_b32 s21, s43, 0xffff
    s_mov_b32 s22, 0x280000
    s_mov_b32 s23, 0x20000
    buffer_load_dwordx2 v[36:37], v13, s[20:23], s58 offen offset:0
    buffer_load_dwordx2 v[38:39], v13, s[20:23], s58 offen offset:16
    buffer_load_dwordx2 v[40:41], v13, s[20:23], s58 offen offset:32
    buffer_load_dwordx2 v[42:43], v13, s[20:23], s58 offen offset:48
    buffer_load_dwordx2 v[44:45], v13, s[20:23], s58 offen offset:64
    s_mov_b32 s24, s38
    s_and_b32 s25, s39, 0xffff
    s_mov_b32 s26, 0x1000
    s_mov_b32 s27, 0x20000
    v_and_b32 v4, 31, v0
    v_lshlrev_b32 v4, 1, v4
    buffer_load_ushort v15, v4, s[24:27], s50 offen
    s_and_b32 s29, s29, 0xffff
    s_mov_b32 s30, 2621440
    s_mov_b32 s31, 0x20000
    s_mul_i32 s48, s46, 1572864
    s_lshl_b32 s55, s51, 7
    s_add_u32 s48, s48, s55
    s_lshl_b32 s49, s52, 18
    s_lshl_b32 s55, s46, 15
    s_add_u32 s49, s49, s55
    s_add_u32 s49, s49, 524288
    s_mov_b32 s20, s32
    s_and_b32 s21, s33, 0xffff
    s_mov_b32 s22, 0x600000
    s_mov_b32 s23, 0x20000
    s_mov_b32 s24, s34
    s_and_b32 s25, s35, 0xffff
    s_mov_b32 s26, 0xc00
    s_mov_b32 s27, 0x20000
    s_cmp_ge_u32 s12, 30
    s_cbranch_scc1 L_m2
    v_lshrrev_b32 v4, 5, v0
    v_lshlrev_b32 v4, 3, v4
    s_lshr_b32 s55, s46, 1
    s_lshl_b32 s55, s55, 6
    s_lshl_b32 s56, s51, 7
    s_add_u32 s55, s55, s56
    buffer_load_dwordx2 v[212:213], v4, s[24:27], s55 offen offset:0
    buffer_load_dwordx2 v[214:215], v4, s[24:27], s55 offen offset:16
    buffer_load_dwordx2 v[216:217], v4, s[24:27], s55 offen offset:32
    buffer_load_dwordx2 v[218:219], v4, s[24:27], s55 offen offset:48
    v_and_b32 v4, 15, v0
    v_lshlrev_b32 v4, 7, v4
    s_lshl_b32 s55, s46, 11
    s_add_u32 s55, s55, 8421376
    s_mov_b32 s57, 0
L_pf13:
    buffer_load_dwordx4 v[8:11], v4, s[4:7], s55 offen sc1
    s_add_u32 s57, s57, 1
    s_waitcnt vmcnt(0)
    v_cmp_ne_u32 vcc, s11, v8
    v_xor_b32 v9, s11, v9
    v_xor_b32 v10, s11, v10
    v_xor_b32 v11, s11, v11
    v_or3_b32 v9, v9, v10, v11
    v_cmp_ne_u32 s[18:19], 0, v9
    s_nop 1
    s_or_b64 vcc, vcc, s[18:19]
    s_cmp_ge_u32 s57, 65536
    s_cbranch_scc1 L_pf13_ok
    s_nop 1
    s_cbranch_vccz L_pf13_ok
    s_sleep 2
    s_branch L_pf13
L_pf13_ok:
    v_lshlrev_b32 v196, 16, v212
    v_and_b32 v197, 0xffff0000, v212
    v_lshlrev_b32 v198, 16, v213
    v_and_b32 v199, 0xffff0000, v213
    v_lshlrev_b32 v200, 16, v214
    v_and_b32 v201, 0xffff0000, v214
    v_lshlrev_b32 v202, 16, v215
    v_and_b32 v203, 0xffff0000, v215
    v_lshlrev_b32 v204, 16, v216
    v_and_b32 v205, 0xffff0000, v216
    v_lshlrev_b32 v206, 16, v217
    v_and_b32 v207, 0xffff0000, v217
    v_lshlrev_b32 v208, 16, v218
    v_and_b32 v209, 0xffff0000, v218
    v_lshlrev_b32 v210, 16, v219
    v_and_b32 v211, 0xffff0000, v219
    s_mov_b32 s57, 0
L_sp14:
    ds_read_b32 v6, v1 offset:24
    s_add_u32 s57, s57, 1
    s_waitcnt lgkmcnt(0)
    v_readfirstlane_b32 s56, v6
    s_cmp_ge_u32 s57, 1048576
    s_cbranch_scc1 L_sp14_ok
    s_cmp_ge_u32 s56, 4
    s_cbranch_scc0 L_sp14
L_sp14_ok:
    s_add_u32 m0, s47, 0
    s_nop 0
    buffer_load_dwordx4 v20, s[20:23], s48 offen lds
    s_add_u32 m0, s47, 1024
    s_add_u32 s48, s48, 24576
    buffer_load_dwordx4 v20, s[20:23], s48 offen lds
    s_add_u32 s48, s48, 24576
    buffer_load_dwordx4 v[68:71], v3, s[4:7], s49 offen sc1
    buffer_load_dwordx4 v[72:75], v23, s[4:7], s49 offen sc1
    s_add_u32 s49, s49, 1024
    s_add_u32 m0, s47, 2048
    s_nop 0
    buffer_load_dwordx4 v20, s[20:23], s48 offen lds
    s_add_u32 m0, s47, 3072
    s_add_u32 s48, s48, 24576
    buffer_load_dwordx4 v20, s[20:23], s48 offen lds
    s_add_u32 s48, s48, 24576
    buffer_load_dwordx4 v[76:79], v3, s[4:7], s49 offen sc1
    buffer_load_dwordx4 v[80:83], v23, s[4:7], s49 offen sc1
    s_add_u32 s49, s49, 1024
    s_add_u32 m0, s47, 4096
    s_nop 0
    buffer_load_dwordx4 v20, s[20:23], s48 offen lds
    s_add_u32 m0, s47, 5120
    s_add_u32 s48, s48, 24576
    buffer_load_dwordx4 v20, s[20:23], s48 offen lds
    s_add_u32 s48, s48, 24576
    buffer_load_dwordx4 v[84:87], v3, s[4:7], s49 offen sc1
    buffer_load_dwordx4 v[88:91], v23, s[4:7], s49 offen sc1
    s_add_u32 s49, s49, 1024
    s_add_u32 m0, s47, 6144
    s_nop 0
    buffer_load_dwordx4 v20, s[20:23], s48 offen lds
    s_add_u32 m0, s47, 7168
    s_add_u32 s48, s48, 24576
    buffer_load_dwordx4 v20, s[20:23], s48 offen lds
    s_add_u32 s48, s48, 24576
    buffer_load_dwordx4 v[92:95], v3, s[4:7], s49 offen sc1
    buffer_load_dwordx4 v[96:99], v23, s[4:7], s49 offen sc1
    s_add_u32 s49, s49, 1024
    s_add_u32 m0, s47, 8192
    s_nop 0
    buffer_load_dwordx4 v20, s[20:23], s48 offen lds
    s_add_u32 m0, s47, 9216
    s_add_u32 s48, s48, 24576
    buffer_load_dwordx4 v20, s[20:23], s48 offen lds
    s_add_u32 s48, s48, 24576
    buffer_load_dwordx4 v[100:103], v3, s[4:7], s49 offen sc1
    buffer_load_dwordx4 v[104:107], v23, s[4:7], s49 offen sc1
    s_add_u32 s49, s49, 1024
    s_add_u32 m0, s47, 10240
    s_nop 0
    buffer_load_dwordx4 v20, s[20:23], s48 offen lds
    s_add_u32 m0, s47, 11264
    s_add_u32 s48, s48, 24576
    buffer_load_dwordx4 v20, s[20:23], s48 offen lds
    s_add_u32 s48, s48, 24576
    buffer_load_dwordx4 v[108:111], v3, s[4:7], s49 offen sc1
    buffer_load_dwordx4 v[112:115], v23, s[4:7], s49 offen sc1
    s_add_u32 s49, s49, 1024
    s_add_u32 m0, s47, 12288
    s_nop 0
    buffer_load_dwordx4 v20, s[20:23], s48 offen lds
    s_add_u32 m0, s47, 13312
    s_add_u32 s48, s48, 24576
    buffer_load_dwordx4 v20, s[20:23], s48 offen lds
    s_add_u32 s48, s48, 24576
    buffer_load_dwordx4 v[116:119], v3, s[4:7], s49 offen sc1
    buffer_load_dwordx4 v[120:123], v23, s[4:7], s49 offen sc1
    s_add_u32 s49, s49, 1024
    s_add_u32 m0, s47, 14336
    s_nop 0
    buffer_load_dwordx4 v20, s[20:23], s48 offen lds
    s_add_u32 m0, s47, 15360
    s_add_u32 s48, s48, 24576
    buffer_load_dwordx4 v20, s[20:23], s48 offen lds
    s_add_u32 s48, s48, 24576
    buffer_load_dwordx4 v[124:127], v3, s[4:7], s49 offen sc1
    buffer_load_dwordx4 v[128:131], v23, s[4:7], s49 offen sc1
    s_add_u32 s49, s49, 1024
    s_waitcnt vmcnt(28)
    ds_read_b64_tr_b16 v[52:53], v21 offset:0
    ds_read_b64_tr_b16 v[54:55], v21 offset:512
    ds_read_b64_tr_b16 v[56:57], v22 offset:0
    ds_read_b64_tr_b16 v[58:59], v22 offset:512
    s_waitcnt vmcnt(24)
    ds_read_b64_tr_b16 v[60:61], v21 offset:2048
    ds_read_b64_tr_b16 v[62:63], v21 offset:2560
    ds_read_b64_tr_b16 v[64:65], v22 offset:2048
    ds_read_b64_tr_b16 v[66:67], v22 offset:2560
    s_waitcnt lgkmcnt(4)
    v_mfma_f32_32x32x16_bf16 v[132:147], v[52:55], v[68:71], 0
    v_mfma_f32_32x32x16_bf16 v[148:163], v[52:55], v[72:75], 0
    v_mfma_f32_32x32x16_bf16 v[164:179], v[56:59], v[68:71], 0
    v_mfma_f32_32x32x16_bf16 v[180:195], v[56:59], v[72:75], 0
    s_add_u32 m0, s47, 0
    s_nop 0
    buffer_load_dwordx4 v20, s[20:23], s48 offen lds
    s_add_u32 m0, s47, 1024
    s_add_u32 s48, s48, 24576
    buffer_load_dwordx4 v20, s[20:23], s48 offen lds
    s_add_u32 s48, s48, 24576
    buffer_load_dwordx4 v[68:71], v3, s[4:7], s49 offen sc1
    buffer_load_dwordx4 v[72:75], v23, s[4:7], s49 offen sc1
    s_add_u32 s49, s49, 1024
    s_waitcnt vmcnt(24)
    ds_read_b64_tr_b16 v[52:53], v21 offset:4096
    ds_read_b64_tr_b16 v[54:55], v21 offset:4608
    ds_read_b64_tr_b16 v[56:57], v22 offset:4096
    ds_read_b64_tr_b16 v[58:59], v22 offset:4608
    s_waitcnt lgkmcnt(4)
    v_mfma_f32_32x32x16_bf16 v[132:147], v[60:63], v[76:79], v[132:147]
    v_mfma_f32_32x32x16_bf16 v[148:163], v[60:63], v[80:83], v[148:163]
    v_mfma_f32_32x32x16_bf16 v[164:179], v[64:67], v[76:79], v[164:179]
    v_mfma_f32_32x32x16_bf16 v[180:195], v[64:67], v[80:83], v[180:195]
    s_add_u32 m0, s47, 2048
    s_nop 0
    buffer_load_dwordx4 v20, s[20:23], s48 offen lds
    s_add_u32 m0, s47, 3072
    s_add_u32 s48, s48, 24576
    buffer_load_dwordx4 v20, s[20:23], s48 offen lds
    s_add_u32 s48, s48, 24576
    buffer_load_dwordx4 v[76:79], v3, s[4:7], s49 offen sc1
    buffer_load_dwordx4 v[80:83], v23, s[4:7], s49 offen sc1
    s_add_u32 s49, s49, 1024
    s_waitcnt vmcnt(24)
    ds_read_b64_tr_b16 v[60:61], v21 offset:6144
    ds_read_b64_tr_b16 v[62:63], v21 offset:6656
    ds_read_b64_tr_b16 v[64:65], v22 offset:6144
    ds_read_b64_tr_b16 v[66:67], v22 offset:6656
    s_waitcnt lgkmcnt(4)
    v_mfma_f32_32x32x16_bf16 v[132:147], v[52:55], v[84:87], v[132:147]
    v_mfma_f32_32x32x16_bf16 v[148:163], v[52:55], v[88:91], v[148:163]
    v_mfma_f32_32x32x16_bf16 v[164:179], v[56:59], v[84:87], v[164:179]
    v_mfma_f32_32x32x16_bf16 v[180:195], v[56:59], v[88:91], v[180:195]
    s_add_u32 m0, s47, 4096
    s_nop 0
    buffer_load_dwordx4 v20, s[20:23], s48 offen lds
    s_add_u32 m0, s47, 5120
    s_add_u32 s48, s48, 24576
    buffer_load_dwordx4 v20, s[20:23], s48 offen lds
    s_add_u32 s48, s48, 24576
    buffer_load_dwordx4 v[84:87], v3, s[4:7], s49 offen sc1
    buffer_load_dwordx4 v[88:91], v23, s[4:7], s49 offen sc1
    s_add_u32 s49, s49, 1024
    s_waitcnt vmcnt(24)
    ds_read_b64_tr_b16 v[52:53], v21 offset:8192
    ds_read_b64_tr_b16 v[54:55], v21 offset:8704
    ds_read_b64_tr_b16 v[56:57], v22 offset:8192
    ds_read_b64_tr_b16 v[58:59], v22 offset:8704
    s_waitcnt lgkmcnt(4)
    v_mfma_f32_32x32x16_bf16 v[132:147], v[60:63], v[92:95], v[132:147]
    v_mfma_f32_32x32x16_bf16 v[148:163], v[60:63], v[96:99], v[148:163]
    v_mfma_f32_32x32x16_bf16 v[164:179], v[64:67], v[92:95], v[164:179]
    v_mfma_f32_32x32x16_bf16 v[180:195], v[64:67], v[96:99], v[180:195]
    s_add_u32 m0, s47, 6144
    s_nop 0
    buffer_load_dwordx4 v20, s[20:23], s48 offen lds
    s_add_u32 m0, s47, 7168
    s_add_u32 s48, s48, 24576
    buffer_load_dwordx4 v20, s[20:23], s48 offen lds
    s_add_u32 s48, s48, 24576
    buffer_load_dwordx4 v[92:95], v3, s[4:7], s49 offen sc1
    buffer_load_dwordx4 v[96:99], v23, s[4:7], s49 offen sc1
    s_add_u32 s49, s49, 1024
    s_waitcnt vmcnt(24)
    ds_read_b64_tr_b16 v[60:61], v21 offset:10240
    ds_read_b64_tr_b16 v[62:63], v21 offset:10752
    ds_read_b64_tr_b16 v[64:65], v22 offset:10240
    ds_read_b64_tr_b16 v[66:67], v22 offset:10752
    s_waitcnt lgkmcnt(4)
    v_mfma_f32_32x32x16_bf16 v[132:147], v[52:55], v[100:103], v[132:147]
    v_mfma_f32_32x32x16_bf16 v[148:163], v[52:55], v[104:107], v[148:163]
    v_mfma_f32_32x32x16_bf16 v[164:179], v[56:59], v[100:103], v[164:179]
    v_mfma_f32_32x32x16_bf16 v[180:195], v[56:59], v[104:107], v[180:195]
    s_add_u32 m0, s47, 8192
    s_nop 0
    buffer_load_dwordx4 v20, s[20:23], s48 offen lds
    s_add_u32 m0, s47, 9216
    s_add_u32 s48, s48, 24576
    buffer_load_dwordx4 v20, s[20:23], s48 offen lds
    s_add_u32 s48, s48, 24576
    buffer_load_dwordx4 v[100:103], v3, s[4:7], s49 offen sc1
    buffer_load_dwordx4 v[104:107], v23, s[4:7], s49 offen sc1
    s_add_u32 s49, s49, 1024
    s_waitcnt vmcnt(24)
    ds_read_b64_tr_b16 v[52:53], v21 offset:12288
    ds_read_b64_tr_b16 v[54:55], v21 offset:12800
    ds_read_b64_tr_b16 v[56:57], v22 offset:12288
    ds_read_b64_tr_b16 v[58:59], v22 offset:12800
    s_waitcnt lgkmcnt(4)
    v_mfma_f32_32x32x16_bf16 v[132:147], v[60:63], v[108:111], v[132:147]
    v_mfma_f32_32x32x16_bf16 v[148:163], v[60:63], v[112:115], v[148:163]
    v_mfma_f32_32x32x16_bf16 v[164:179], v[64:67], v[108:111], v[164:179]
    v_mfma_f32_32x32x16_bf16 v[180:195], v[64:67], v[112:115], v[180:195]
    s_add_u32 m0, s47, 10240
    s_nop 0
    buffer_load_dwordx4 v20, s[20:23], s48 offen lds
    s_add_u32 m0, s47, 11264
    s_add_u32 s48, s48, 24576
    buffer_load_dwordx4 v20, s[20:23], s48 offen lds
    s_add_u32 s48, s48, 24576
    buffer_load_dwordx4 v[108:111], v3, s[4:7], s49 offen sc1
    buffer_load_dwordx4 v[112:115], v23, s[4:7], s49 offen sc1
    s_add_u32 s49, s49, 1024
    s_waitcnt vmcnt(24)
    ds_read_b64_tr_b16 v[60:61], v21 offset:14336
    ds_read_b64_tr_b16 v[62:63], v21 offset:14848
    ds_read_b64_tr_b16 v[64:65], v22 offset:14336
    ds_read_b64_tr_b16 v[66:67], v22 offset:14848
    s_waitcnt lgkmcnt(4)
    v_mfma_f32_32x32x16_bf16 v[132:147], v[52:55], v[116:119], v[132:147]
    v_mfma_f32_32x32x16_bf16 v[148:163], v[52:55], v[120:123], v[148:163]
    v_mfma_f32_32x32x16_bf16 v[164:179], v[56:59], v[116:119], v[164:179]
    v_mfma_f32_32x32x16_bf16 v[180:195], v[56:59], v[120:123], v[180:195]
    s_add_u32 m0, s47, 12288
    s_nop 0
    buffer_load_dwordx4 v20, s[20:23], s48 offen lds
    s_add_u32 m0, s47, 13312
    s_add_u32 s48, s48, 24576
    buffer_load_dwordx4 v20, s[20:23], s48 offen lds
    s_add_u32 s48, s48, 24576
    buffer_load_dwordx4 v[116:119], v3, s[4:7], s49 offen sc1
    buffer_load_dwordx4 v[120:123], v23, s[4:7], s49 offen sc1
    s_add_u32 s49, s49, 1024
    s_waitcnt vmcnt(24)
    ds_read_b64_tr_b16 v[52:53], v21 offset:0
    ds_read_b64_tr_b16 v[54:55], v21 offset:512
    ds_read_b64_tr_b16 v[56:57], v22 offset:0
    ds_read_b64_tr_b16 v[58:59], v22 offset:512
    s_waitcnt lgkmcnt(4)
    v_mfma_f32_32x32x16_bf16 v[132:147], v[60:63], v[124:127], v[132:147]
    v_mfma_f32_32x32x16_bf16 v[148:163], v[60:63], v[128:131], v[148:163]
    v_mfma_f32_32x32x16_bf16 v[164:179], v[64:67], v[124:127], v[164:179]
    v_mfma_f32_32x32x16_bf16 v[180:195], v[64:67], v[128:131], v[180:195]
    s_add_u32 m0, s47, 14336
    s_nop 0
    buffer_load_dwordx4 v20, s[20:23], s48 offen lds
    s_add_u32 m0, s47, 15360
    s_add_u32 s48, s48, 24576
    buffer_load_dwordx4 v20, s[20:23], s48 offen lds
    s_add_u32 s48, s48, 24576
    buffer_load_dwordx4 v[124:127], v3, s[4:7], s49 offen sc1
    buffer_load_dwordx4 v[128:131], v23, s[4:7], s49 offen sc1
    s_add_u32 s49, s49, 1024
    s_mov_b32 s50, 2
L_m1_loop:
    s_waitcnt vmcnt(24)
    ds_read_b64_tr_b16 v[60:61], v21 offset:2048
    ds_read_b64_tr_b16 v[62:63], v21 offset:2560
    ds_read_b64_tr_b16 v[64:65], v22 offset:2048
    ds_read_b64_tr_b16 v[66:67], v22 offset:2560
    s_waitcnt lgkmcnt(4)
    v_mfma_f32_32x32x16_bf16 v[132:147], v[52:55], v[68:71], v[132:147]
    v_mfma_f32_32x32x16_bf16 v[148:163], v[52:55], v[72:75], v[148:163]
    v_mfma_f32_32x32x16_bf16 v[164:179], v[56:59], v[68:71], v[164:179]
    v_mfma_f32_32x32x16_bf16 v[180:195], v[56:59], v[72:75], v[180:195]
    s_add_u32 m0, s47, 0
    s_nop 0
    buffer_load_dwordx4 v20, s[20:23], s48 offen lds
    s_add_u32 m0, s47, 1024
    s_add_u32 s48, s48, 24576
    buffer_load_dwordx4 v20, s[20:23], s48 offen lds
    s_add_u32 s48, s48, 24576
    buffer_load_dwordx4 v[68:71], v3, s[4:7], s49 offen sc1
    buffer_load_dwordx4 v[72:75], v23, s[4:7], s49 offen sc1
    s_add_u32 s49, s49, 1024
    s_waitcnt vmcnt(24)
    ds_read_b64_tr_b16 v[52:53], v21 offset:4096
    ds_read_b64_tr_b16 v[54:55], v21 offset:4608
    ds_read_b64_tr_b16 v[56:57], v22 offset:4096
    ds_read_b64_tr_b16 v[58:59], v22 offset:4608
    s_waitcnt lgkmcnt(4)
    v_mfma_f32_32x32x16_bf16 v[132:147], v[60:63], v[76:79], v[132:147]
    v_mfma_f32_32x32x16_bf16 v[148:163], v[60:63], v[80:83], v[148:163]
    v_mfma_f32_32x32x16_bf16 v[164:179], v[64:67], v[76:79], v[164:179]
    v_mfma_f32_32x32x16_bf16 v[180:195], v[64:67], v[80:83], v[180:195]
    s_add_u32 m0, s47, 2048
    s_nop 0
    buffer_load_dwordx4 v20, s[20:23], s48 offen lds
    s_add_u32 m0, s47, 3072
    s_add_u32 s48, s48, 24576
    buffer_load_dwordx4 v20, s[20:23], s48 offen lds
    s_add_u32 s48, s48, 24576
    buffer_load_dwordx4 v[76:79], v3, s[4:7], s49 offen sc1
    buffer_load_dwordx4 v[80:83], v23, s[4:7], s49 offen sc1
    s_add_u32 s49, s49, 1024
    s_waitcnt vmcnt(24)
    ds_read_b64_tr_b16 v[60:61], v21 offset:6144
    ds_read_b64_tr_b16 v[62:63], v21 offset:6656
    ds_read_b64_tr_b16 v[64:65], v22 offset:6144
    ds_read_b64_tr_b16 v[66:67], v22 offset:6656
    s_waitcnt lgkmcnt(4)
    v_mfma_f32_32x32x16_bf16 v[132:147], v[52:55], v[84:87], v[132:147]
    v_mfma_f32_32x32x16_bf16 v[148:163], v[52:55], v[88:91], v[148:163]
    v_mfma_f32_32x32x16_bf16 v[164:179], v[56:59], v[84:87], v[164:179]
    v_mfma_f32_32x32x16_bf16 v[180:195], v[56:59], v[88:91], v[180:195]
    s_add_u32 m0, s47, 4096
    s_nop 0
    buffer_load_dwordx4 v20, s[20:23], s48 offen lds
    s_add_u32 m0, s47, 5120
    s_add_u32 s48, s48, 24576
    buffer_load_dwordx4 v20, s[20:23], s48 offen lds
    s_add_u32 s48, s48, 24576
    buffer_load_dwordx4 v[84:87], v3, s[4:7], s49 offen sc1
    buffer_load_dwordx4 v[88:91], v23, s[4:7], s49 offen sc1
    s_add_u32 s49, s49, 1024
    s_waitcnt vmcnt(24)
    ds_read_b64_tr_b16 v[52:53], v21 offset:8192
    ds_read_b64_tr_b16 v[54:55], v21 offset:8704
    ds_read_b64_tr_b16 v[56:57], v22 offset:8192
    ds_read_b64_tr_b16 v[58:59], v22 offset:8704
    s_waitcnt lgkmcnt(4)
    v_mfma_f32_32x32x16_bf16 v[132:147], v[60:63], v[92:95], v[132:147]
    v_mfma_f32_32x32x16_bf16 v[148:163], v[60:63], v[96:99], v[148:163]
    v_mfma_f32_32x32x16_bf16 v[164:179], v[64:67], v[92:95], v[164:179]
    v_mfma_f32_32x32x16_bf16 v[180:195], v[64:67], v[96:99], v[180:195]
    s_add_u32 m0, s47, 6144
    s_nop 0
    buffer_load_dwordx4 v20, s[20:23], s48 offen lds
    s_add_u32 m0, s47, 7168
    s_add_u32 s48, s48, 24576
    buffer_load_dwordx4 v20, s[20:23], s48 offen lds
    s_add_u32 s48, s48, 24576
    buffer_load_dwordx4 v[92:95], v3, s[4:7], s49 offen sc1
    buffer_load_dwordx4 v[96:99], v23, s[4:7], s49 offen sc1
    s_add_u32 s49, s49, 1024
    s_waitcnt vmcnt(24)
    ds_read_b64_tr_b16 v[60:61], v21 offset:10240
    ds_read_b64_tr_b16 v[62:63], v21 offset:10752
    ds_read_b64_tr_b16 v[64:65], v22 offset:10240
    ds_read_b64_tr_b16 v[66:67], v22 offset:10752
    s_waitcnt lgkmcnt(4)
    v_mfma_f32_32x32x16_bf16 v[132:147], v[52:55], v[100:103], v[132:147]
    v_mfma_f32_32x32x16_bf16 v[148:163], v[52:55], v[104:107], v[148:163]
    v_mfma_f32_32x32x16_bf16 v[164:179], v[56:59], v[100:103], v[164:179]
    v_mfma_f32_32x32x16_bf16 v[180:195], v[56:59], v[104:107], v[180:195]
    s_add_u32 m0, s47, 8192
    s_nop 0
    buffer_load_dwordx4 v20, s[20:23], s48 offen lds
    s_add_u32 m0, s47, 9216
    s_add_u32 s48, s48, 24576
    buffer_load_dwordx4 v20, s[20:23], s48 offen lds
    s_add_u32 s48, s48, 24576
    buffer_load_dwordx4 v[100:103], v3, s[4:7], s49 offen sc1
    buffer_load_dwordx4 v[104:107], v23, s[4:7], s49 offen sc1
    s_add_u32 s49, s49, 1024
    s_waitcnt vmcnt(24)
    ds_read_b64_tr_b16 v[52:53], v21 offset:12288
    ds_read_b64_tr_b16 v[54:55], v21 offset:12800
    ds_read_b64_tr_b16 v[56:57], v22 offset:12288
    ds_read_b64_tr_b16 v[58:59], v22 offset:12800
    s_waitcnt lgkmcnt(4)
    v_mfma_f32_32x32x16_bf16 v[132:147], v[60:63], v[108:111], v[132:147]
    v_mfma_f32_32x32x16_bf16 v[148:163], v[60:63], v[112:115], v[148:163]
    v_mfma_f32_32x32x16_bf16 v[164:179], v[64:67], v[108:111], v[164:179]
    v_mfma_f32_32x32x16_bf16 v[180:195], v[64:67], v[112:115], v[180:195]
    s_add_u32 m0, s47, 10240
    s_nop 0
    buffer_load_dwordx4 v20, s[20:23], s48 offen lds
    s_add_u32 m0, s47, 11264
    s_add_u32 s48, s48, 24576
    buffer_load_dwordx4 v20, s[20:23], s48 offen lds
    s_add_u32 s48, s48, 24576
    buffer_load_dwordx4 v[108:111], v3, s[4:7], s49 offen sc1
    buffer_load_dwordx4 v[112:115], v23, s[4:7], s49 offen sc1
    s_add_u32 s49, s49, 1024
    s_waitcnt vmcnt(24)
    ds_read_b64_tr_b16 v[60:61], v21 offset:14336
    ds_read_b64_tr_b16 v[62:63], v21 offset:14848
    ds_read_b64_tr_b16 v[64:65], v22 offset:14336
    ds_read_b64_tr_b16 v[66:67], v22 offset:14848
    s_waitcnt lgkmcnt(4)
    v_mfma_f32_32x32x16_bf16 v[132:147], v[52:55], v[116:119], v[132:147]
    v_mfma_f32_32x32x16_bf16 v[148:163], v[52:55], v[120:123], v[148:163]
    v_mfma_f32_32x32x16_bf16 v[164:179], v[56:59], v[116:119], v[164:179]
    v_mfma_f32_32x32x16_bf16 v[180:195], v[56:59], v[120:123], v[180:195]
    s_add_u32 m0, s47, 12288
    s_nop 0
    buffer_load_dwordx4 v20, s[20:23], s48 offen lds
    s_add_u32 m0, s47, 13312
    s_add_u32 s48, s48, 24576
    buffer_load_dwordx4 v20, s[20:23], s48 offen lds
    s_add_u32 s48, s48, 24576
    buffer_load_dwordx4 v[116:119], v3, s[4:7], s49 offen sc1
    buffer_load_dwordx4 v[120:123], v23, s[4:7], s49 offen sc1
    s_add_u32 s49, s49, 1024
    s_waitcnt vmcnt(24)
    ds_read_b64_tr_b16 v[52:53], v21 offset:0
    ds_read_b64_tr_b16 v[54:55], v21 offset:512
    ds_read_b64_tr_b16 v[56:57], v22 offset:0
    ds_read_b64_tr_b16 v[58:59], v22 offset:512
    s_waitcnt lgkmcnt(4)
    v_mfma_f32_32x32x16_bf16 v[132:147], v[60:63], v[124:127], v[132:147]
    v_mfma_f32_32x32x16_bf16 v[148:163], v[60:63], v[128:131], v[148:163]
    v_mfma_f32_32x32x16_bf16 v[164:179], v[64:67], v[124:127], v[164:179]
    v_mfma_f32_32x32x16_bf16 v[180:195], v[64:67], v[128:131], v[180:195]
    s_add_u32 m0, s47, 14336
    s_nop 0
    buffer_load_dwordx4 v20, s[20:23], s48 offen lds
    s_add_u32 m0, s47, 15360
    s_add_u32 s48, s48, 24576
    buffer_load_dwordx4 v20, s[20:23], s48 offen lds
    s_add_u32 s48, s48, 24576
    buffer_load_dwordx4 v[124:127], v3, s[4:7], s49 offen sc1
    buffer_load_dwordx4 v[128:131], v23, s[4:7], s49 offen sc1
    s_add_u32 s49, s49, 1024
    s_sub_u32 s50, s50, 1
    s_cmp_lg_u32 s50, 0
    s_cbranch_scc1 L_m1_loop
    s_waitcnt vmcnt(24)
    ds_read_b64_tr_b16 v[60:61], v21 offset:2048
    ds_read_b64_tr_b16 v[62:63], v21 offset:2560
    ds_read_b64_tr_b16 v[64:65], v22 offset:2048
    ds_read_b64_tr_b16 v[66:67], v22 offset:2560
    s_waitcnt lgkmcnt(4)
    v_mfma_f32_32x32x16_bf16 v[132:147], v[52:55], v[68:71], v[132:147]
    v_mfma_f32_32x32x16_bf16 v[148:163], v[52:55], v[72:75], v[148:163]
    v_mfma_f32_32x32x16_bf16 v[164:179], v[56:59], v[68:71], v[164:179]
    v_mfma_f32_32x32x16_bf16 v[180:195], v[56:59], v[72:75], v[180:195]
    s_waitcnt vmcnt(20)
    ds_read_b64_tr_b16 v[52:53], v21 offset:4096
    ds_read_b64_tr_b16 v[54:55], v21 offset:4608
    ds_read_b64_tr_b16 v[56:57], v22 offset:4096
    ds_read_b64_tr_b16 v[58:59], v22 offset:4608
    s_waitcnt lgkmcnt(4)
    v_mfma_f32_32x32x16_bf16 v[132:147], v[60:63], v[76:79], v[132:147]
    v_mfma_f32_32x32x16_bf16 v[148:163], v[60:63], v[80:83], v[148:163]
    v_mfma_f32_32x32x16_bf16 v[164:179], v[64:67], v[76:79], v[164:179]
    v_mfma_f32_32x32x16_bf16 v[180:195], v[64:67], v[80:83], v[180:195]
    s_waitcnt vmcnt(16)
    ds_read_b64_tr_b16 v[60:61], v21 offset:6144
    ds_read_b64_tr_b16 v[62:63], v21 offset:6656
    ds_read_b64_tr_b16 v[64:65], v22 offset:6144
    ds_read_b64_tr_b16 v[66:67], v22 offset:6656
    s_waitcnt lgkmcnt(4)
    v_mfma_f32_32x32x16_bf16 v[132:147], v[52:55], v[84:87], v[132:147]
    v_mfma_f32_32x32x16_bf16 v[148:163], v[52:55], v[88:91], v[148:163]
    v_mfma_f32_32x32x16_bf16 v[164:179], v[56:59], v[84:87], v[164:179]
    v_mfma_f32_32x32x16_bf16 v[180:195], v[56:59], v[88:91], v[180:195]
    s_waitcnt vmcnt(12)
    ds_read_b64_tr_b16 v[52:53], v21 offset:8192
    ds_read_b64_tr_b16 v[54:55], v21 offset:8704
    ds_read_b64_tr_b16 v[56:57], v22 offset:8192
    ds_read_b64_tr_b16 v[58:59], v22 offset:8704
    s_waitcnt lgkmcnt(4)
    v_mfma_f32_32x32x16_bf16 v[132:147], v[60:63], v[92:95], v[132:147]
    v_mfma_f32_32x32x16_bf16 v[148:163], v[60:63], v[96:99], v[148:163]
    v_mfma_f32_32x32x16_bf16 v[164:179], v[64:67], v[92:95], v[164:179]
    v_mfma_f32_32x32x16_bf16 v[180:195], v[64:67], v[96:99], v[180:195]
    s_waitcnt vmcnt(8)
    ds_read_b64_tr_b16 v[60:61], v21 offset:10240
    ds_read_b64_tr_b16 v[62:63], v21 offset:10752
    ds_read_b64_tr_b16 v[64:65], v22 offset:10240
    ds_read_b64_tr_b16 v[66:67], v22 offset:10752
    s_waitcnt lgkmcnt(4)
    v_mfma_f32_32x32x16_bf16 v[132:147], v[52:55], v[100:103], v[132:147]
    v_mfma_f32_32x32x16_bf16 v[148:163], v[52:55], v[104:107], v[148:163]
    v_mfma_f32_32x32x16_bf16 v[164:179], v[56:59], v[100:103], v[164:179]
    v_mfma_f32_32x32x16_bf16 v[180:195], v[56:59], v[104:107], v[180:195]
    s_waitcnt vmcnt(4)
    ds_read_b64_tr_b16 v[52:53], v21 offset:12288
    ds_read_b64_tr_b16 v[54:55], v21 offset:12800
    ds_read_b64_tr_b16 v[56:57], v22 offset:12288
    ds_read_b64_tr_b16 v[58:59], v22 offset:12800
    s_waitcnt lgkmcnt(4)
    v_mfma_f32_32x32x16_bf16 v[132:147], v[60:63], v[108:111], v[132:147]
    v_mfma_f32_32x32x16_bf16 v[148:163], v[60:63], v[112:115], v[148:163]
    v_mfma_f32_32x32x16_bf16 v[164:179], v[64:67], v[108:111], v[164:179]
    v_mfma_f32_32x32x16_bf16 v[180:195], v[64:67], v[112:115], v[180:195]
    s_waitcnt vmcnt(0)
    ds_read_b64_tr_b16 v[60:61], v21 offset:14336
    ds_read_b64_tr_b16 v[62:63], v21 offset:14848
    ds_read_b64_tr_b16 v[64:65], v22 offset:14336
    ds_read_b64_tr_b16 v[66:67], v22 offset:14848
    s_waitcnt lgkmcnt(4)
    v_mfma_f32_32x32x16_bf16 v[132:147], v[52:55], v[116:119], v[132:147]
    v_mfma_f32_32x32x16_bf16 v[148:163], v[52:55], v[120:123], v[148:163]
    v_mfma_f32_32x32x16_bf16 v[164:179], v[56:59], v[116:119], v[164:179]
    v_mfma_f32_32x32x16_bf16 v[180:195], v[56:59], v[120:123], v[180:195]
    s_waitcnt lgkmcnt(0)
    v_mfma_f32_32x32x16_bf16 v[132:147], v[60:63], v[124:127], v[132:147]
    v_mfma_f32_32x32x16_bf16 v[148:163], v[60:63], v[128:131], v[148:163]
    v_mfma_f32_32x32x16_bf16 v[164:179], v[64:67], v[124:127], v[164:179]
    v_mfma_f32_32x32x16_bf16 v[180:195], v[64:67], v[128:131], v[180:195]
    s_setprio 0
    s_mov_b32 s20, s36
    s_and_b32 s21, s37, 0xffff
    s_mov_b32 s22, 0x600000
    s_mov_b32 s23, 0x20000
    s_lshl_b32 s55, s13, 9
    s_cmp_eq_u32 s46, 3
    s_cbranch_scc1 L_m1_np
    buffer_load_dword v255, v32, s[20:23], s55 offen
L_m1_np:
    s_nop 11
    ds_write_b128 v12, v[132:135] offset:0
    ds_write_b128 v12, v[136:139] offset:1024
    ds_write_b128 v12, v[140:143] offset:2048
    ds_write_b128 v12, v[144:147] offset:3072
    ds_write_b128 v12, v[148:151] offset:4096
    ds_write_b128 v12, v[152:155] offset:5120
    ds_write_b128 v12, v[156:159] offset:6144
    ds_write_b128 v12, v[160:163] offset:7168
    ds_write_b128 v12, v[164:167] offset:8192
    ds_write_b128 v12, v[168:171] offset:9216
    ds_write_b128 v12, v[172:175] offset:10240
    ds_write_b128 v12, v[176:179] offset:11264
    s_waitcnt lgkmcnt(8)
    ds_write_b128 v12, v[180:183] offset:12288
    ds_write_b128 v12, v[184:187] offset:13312
    ds_write_b128 v12, v[188:191] offset:14336
    ds_write_b128 v12, v[192:195] offset:15360
    s_waitcnt lgkmcnt(0)
    s_mov_b64 exec, 1
    ds_add_u32 v1, v2 offset:12
    s_mov_b64 exec, -1
    s_mov_b32 s57, 0
L_sp15:
    ds_read_b32 v6, v1 offset:12
    s_add_u32 s57, s57, 1
    s_waitcnt lgkmcnt(0)
    v_readfirstlane_b32 s56, v6
    s_cmp_ge_u32 s57, 1048576
    s_cbranch_scc1 L_sp15_ok
    s_cmp_ge_u32 s56, 4
    s_cbranch_scc0 L_sp15
L_sp15_ok:
    ds_read_b128 v[132:135], v25 offset:0
    ds_read_b128 v[136:139], v25 offset:1024
    ds_read_b128 v[140:143], v25 offset:2048
    ds_read_b128 v[144:147], v25 offset:3072
    ds_read_b128 v[148:151], v25 offset:16384
    ds_read_b128 v[152:155], v25 offset:17408
    ds_read_b128 v[156:159], v25 offset:18432
    ds_read_b128 v[160:163], v25 offset:19456
    ds_read_b128 v[164:167], v25 offset:32768
    ds_read_b128 v[168:171], v25 offset:33792
    ds_read_b128 v[172:175], v25 offset:34816
    ds_read_b128 v[176:179], v25 offset:35840
    s_waitcnt lgkmcnt(4)
    ds_read_b128 v[180:183], v25 offset:49152
    ds_read_b128 v[184:187], v25 offset:50176
    ds_read_b128 v[188:191], v25 offset:51200
    ds_read_b128 v[192:195], v25 offset:52224
    v_pk_add_f32 v[132:133], v[132:133], v[148:149]
    v_pk_add_f32 v[134:135], v[134:135], v[150:151]
    v_pk_add_f32 v[136:137], v[136:137], v[152:153]
    v_pk_add_f32 v[138:139], v[138:139], v[154:155]
    v_pk_add_f32 v[140:141], v[140:141], v[156:157]
    v_pk_add_f32 v[142:143], v[142:143], v[158:159]
    v_pk_add_f32 v[144:145], v[144:145], v[160:161]
    v_pk_add_f32 v[146:147], v[146:147], v[162:163]
    s_waitcnt lgkmcnt(0)
    s_mov_b64 exec, 1
    ds_add_u32 v1, v2 offset:16
    s_mov_b64 exec, -1
    v_pk_add_f32 v[164:165], v[164:165], v[180:181]
    v_pk_add_f32 v[166:167], v[166:167], v[182:183]
    v_pk_add_f32 v[168:169], v[168:169], v[184:185]
    v_pk_add_f32 v[170:171], v[170:171], v[186:187]
    v_pk_add_f32 v[172:173], v[172:173], v[188:189]
    v_pk_add_f32 v[174:175], v[174:175], v[190:191]
    v_pk_add_f32 v[176:177], v[176:177], v[192:193]
    v_pk_add_f32 v[178:179], v[178:179], v[194:195]
    v_pk_add_f32 v[132:133], v[132:133], v[164:165]
    v_pk_add_f32 v[134:135], v[134:135], v[166:167]
    v_pk_add_f32 v[136:137], v[136:137], v[168:169]
    v_pk_add_f32 v[138:139], v[138:139], v[170:171]
    v_pk_add_f32 v[140:141], v[140:141], v[172:173]
    v_pk_add_f32 v[142:143], v[142:143], v[174:175]
    v_pk_add_f32 v[144:145], v[144:145], v[176:177]
    v_pk_add_f32 v[146:147], v[146:147], v[178:179]
    v_pk_add_f32 v[132:133], v[132:133], v[196:197]
    v_pk_add_f32 v[134:135], v[134:135], v[198:199]
    v_pk_add_f32 v[136:137], v[136:137], v[200:201]
    v_pk_add_f32 v[138:139], v[138:139], v[202:203]
    v_pk_mul_f32 v[4:5], v[132:133], v[132:133]
    v_pk_mul_f32 v[6:7], v[134:135], v[134:135]
    v_pk_mul_f32 v[8:9], v[136:137], v[136:137]
    v_pk_mul_f32 v[10:11], v[138:139], v[138:139]
    v_pk_fma_f32 v[4:5], v[4:5], s[44:45], v[16:17] op_sel_hi:[1,0,0]
    v_pk_fma_f32 v[6:7], v[6:7], s[44:45], v[16:17] op_sel_hi:[1,0,0]
    v_pk_fma_f32 v[8:9], v[8:9], s[44:45], v[16:17] op_sel_hi:[1,0,0]
    v_pk_fma_f32 v[10:11], v[10:11], s[44:45], v[16:17] op_sel_hi:[1,0,0]
    v_pk_mul_f32 v[4:5], v[4:5], v[132:133]
    v_pk_mul_f32 v[6:7], v[6:7], v[134:135]
    v_pk_mul_f32 v[8:9], v[8:9], v[136:137]
    v_pk_mul_f32 v[10:11], v[10:11], v[138:139]
    v_exp_f32 v4, v4
    v_exp_f32 v5, v5
    v_exp_f32 v6, v6
    v_exp_f32 v7, v7
    v_exp_f32 v8, v8
    v_exp_f32 v9, v9
    v_exp_f32 v10, v10
    v_exp_f32 v11, v11
    v_pk_add_f32 v[4:5], v[4:5], v[18:19] op_sel_hi:[1,0]
    v_pk_add_f32 v[6:7], v[6:7], v[18:19] op_sel_hi:[1,0]
    v_pk_add_f32 v[8:9], v[8:9], v[18:19] op_sel_hi:[1,0]
    v_pk_add_f32 v[10:11], v[10:11], v[18:19] op_sel_hi:[1,0]
    v_rcp_f32 v4, v4
    v_rcp_f32 v5, v5
    v_rcp_f32 v6, v6
    v_rcp_f32 v7, v7
    v_rcp_f32 v8, v8
    v_rcp_f32 v9, v9
    v_rcp_f32 v10, v10
    v_rcp_f32 v11, v11
    v_pk_mul_f32 v[132:133], v[132:133], v[4:5]
    v_pk_mul_f32 v[134:135], v[134:135], v[6:7]
    v_pk_mul_f32 v[136:137], v[136:137], v[8:9]
    v_pk_mul_f32 v[138:139], v[138:139], v[10:11]
    v_pk_add_f32 v[140:141], v[140:141], v[204:205]
    v_pk_add_f32 v[142:143], v[142:143], v[206:207]
    v_pk_add_f32 v[144:145], v[144:145], v[208:209]
    v_pk_add_f32 v[146:147], v[146:147], v[210:211]
    v_pk_mul_f32 v[4:5], v[140:141], v[140:141]
    v_pk_mul_f32 v[6:7], v[142:143], v[142:143]
    v_pk_mul_f32 v[8:9], v[144:145], v[144:145]
    v_pk_mul_f32 v[10:11], v[146:147], v[146:147]
    v_pk_fma_f32 v[4:5], v[4:5], s[44:45], v[16:17] op_sel_hi:[1,0,0]
    v_pk_fma_f32 v[6:7], v[6:7], s[44:45], v[16:17] op_sel_hi:[1,0,0]
    v_pk_fma_f32 v[8:9], v[8:9], s[44:45], v[16:17] op_sel_hi:[1,0,0]
    v_pk_fma_f32 v[10:11], v[10:11], s[44:45], v[16:17] op_sel_hi:[1,0,0]
    v_pk_mul_f32 v[4:5], v[4:5], v[140:141]
    v_pk_mul_f32 v[6:7], v[6:7], v[142:143]
    v_pk_mul_f32 v[8:9], v[8:9], v[144:145]
    v_pk_mul_f32 v[10:11], v[10:11], v[146:147]
    v_exp_f32 v4, v4
    v_exp_f32 v5, v5
    v_exp_f32 v6, v6
    v_exp_f32 v7, v7
    v_exp_f32 v8, v8
    v_exp_f32 v9, v9
    v_exp_f32 v10, v10
    v_exp_f32 v11, v11
    v_pk_add_f32 v[4:5], v[4:5], v[18:19] op_sel_hi:[1,0]
    v_pk_add_f32 v[6:7], v[6:7], v[18:19] op_sel_hi:[1,0]
    v_pk_add_f32 v[8:9], v[8:9], v[18:19] op_sel_hi:[1,0]
    v_pk_add_f32 v[10:11], v[10:11], v[18:19] op_sel_hi:[1,0]
    v_rcp_f32 v4, v4
    v_rcp_f32 v5, v5
    v_rcp_f32 v6, v6
    v_rcp_f32 v7, v7
    v_rcp_f32 v8, v8
    v_rcp_f32 v9, v9
    v_rcp_f32 v10, v10
    v_rcp_f32 v11, v11
    v_pk_mul_f32 v[140:141], v[140:141], v[4:5]
    v_pk_mul_f32 v[142:143], v[142:143], v[6:7]
    v_pk_mul_f32 v[144:145], v[144:145], v[8:9]
    v_pk_mul_f32 v[146:147], v[146:147], v[10:11]
    v_cvt_pk_bf16_f32 v148, v132, v133
    v_cvt_pk_bf16_f32 v149, v134, v135
    v_cvt_pk_bf16_f32 v150, v136, v137
    v_cvt_pk_bf16_f32 v151, v138, v139
    v_cvt_pk_bf16_f32 v152, v140, v141
    v_cvt_pk_bf16_f32 v153, v142, v143
    v_cvt_pk_bf16_f32 v154, v144, v145
    v_cvt_pk_bf16_f32 v155, v146, v147
    s_lshr_b32 s55, s46, 1
    s_lshl_b32 s55, s55, 1
    s_lshl_b32 s56, s51, 2
    s_add_u32 s55, s55, s56
    s_lshl_b32 s55, s55, 10
    s_add_u32 s55, s55, 3145728
    buffer_store_dwordx4 v[148:151], v24, s[4:7], s55 offen sc1
    buffer_store_dwordx4 v[152:155], v24, s[4:7], s55 offen offset:1024 sc1
    s_mul_i32 s54, s52, 24
    s_add_u32 s54, s54, s51
    s_lshl_b32 s54, s54, 2
    s_add_u32 s54, s54, s46
    s_lshl_b32 s54, s54, 7
    s_add_u32 s54, s54, 8454144
    s_waitcnt vmcnt(0)
    v_mov_b32 v5, s11
    v_mov_b32 v6, 0
    s_mov_b64 exec, 1
    buffer_store_dword v5, v6, s[4:7], s54 offen sc1
    s_mov_b64 exec, -1
    s_setprio 0
    s_mov_b32 s57, 0
L_sp16:
    ds_read_b32 v6, v1 offset:16
    s_add_u32 s57, s57, 1
    s_waitcnt lgkmcnt(0)
    v_readfirstlane_b32 s56, v6
    s_cmp_ge_u32 s57, 1048576
    s_cbranch_scc1 L_sp16_ok
    s_cmp_ge_u32 s56, 4
    s_cbranch_scc0 L_sp16
L_sp16_ok:
L_m2:
    s_mov_b32 s20, s36
    s_and_b32 s21, s37, 0xffff
    s_mov_b32 s22, 0x600000
    s_mov_b32 s23, 0x20000
    s_mov_b32 s24, s40
    s_and_b32 s25, s41, 0xffff
    s_mov_b32 s26, 0xc8000
    s_mov_b32 s27, 0x20000
    s_mul_i32 s48, s46, 1572864
    s_lshl_b32 s55, s8, 7
    s_add_u32 s48, s48, s55
    s_mul_i32 s49, s9, 294912
    s_mul_i32 s55, s46, 24576
    s_add_u32 s49, s49, s55
    s_add_u32 s49, s49, 3145728
    s_mul_i32 s55, s12, 200
    s_lshl_b32 s56, s46, 6
    s_add_u32 s55, s55, s56
    s_lshl_b32 s55, s55, 7
    v_lshlrev_b32 v4, 3, v3
    s_cmp_eq_u32 s46, 3
    s_cselect_b32 exec_lo, 0xff, -1
    s_cselect_b32 exec_hi, 0, -1
    buffer_load_dword v255, v4, s[24:27], s55 offen
    s_mov_b64 exec, -1
    s_mul_i32 s55, s9, 5
    s_lshr_b32 s55, s55, 2
    s_mul_i32 s55, s55, 12288
    s_mul_i32 s56, s46, 3072
    s_add_u32 s55, s55, s56
    s_add_u32 s55, s55, 8454144
    s_mov_b32 s57, 0
L_pf17:
    buffer_load_dword v5, v31, s[4:7], s55 offen sc1
    s_add_u32 s57, s57, 1
    s_waitcnt vmcnt(0)
    v_cmp_ne_u32 vcc, s11, v5
    s_cmp_ge_u32 s57, 65536
    s_cbranch_scc1 L_pf17_ok
    s_nop 1
    s_cbranch_vccz L_pf17_ok
    s_sleep 1
    s_branch L_pf17
L_pf17_ok:
    s_add_u32 m0, s47, 0
    s_nop 0
    buffer_load_dwordx4 v26, s[20:23], s48 offen lds
    s_add_u32 m0, s47, 1024
    s_add_u32 s48, s48, 32768
    buffer_load_dwordx4 v26, s[20:23], s48 offen lds
    s_add_u32 s48, s48, 32768
    buffer_load_dwordx4 v[76:79], v3, s[4:7], s49 offen sc1
    buffer_load_dwordx4 v[80:83], v29, s[4:7], s49 offen sc1
    buffer_load_dwordx4 v[84:87], v30, s[4:7], s49 offen sc1
    s_add_u32 s49, s49, 1024
    s_add_u32 m0, s47, 2048
    s_nop 0
    buffer_load_dwordx4 v26, s[20:23], s48 offen lds
    s_add_u32 m0, s47, 3072
    s_add_u32 s48, s48, 32768
    buffer_load_dwordx4 v26, s[20:23], s48 offen lds
    s_add_u32 s48, s48, 32768
    buffer_load_dwordx4 v[88:91], v3, s[4:7], s49 offen sc1
    buffer_load_dwordx4 v[92:95], v29, s[4:7], s49 offen sc1
    buffer_load_dwordx4 v[96:99], v30, s[4:7], s49 offen sc1
    s_add_u32 s49, s49, 1024
    s_add_u32 m0, s47, 4096
    s_nop 0
    buffer_load_dwordx4 v26, s[20:23], s48 offen lds
    s_add_u32 m0, s47, 5120
    s_add_u32 s48, s48, 32768
    buffer_load_dwordx4 v26, s[20:23], s48 offen lds
    s_add_u32 s48, s48, 32768
    buffer_load_dwordx4 v[100:103], v3, s[4:7], s49 offen sc1
    buffer_load_dwordx4 v[104:107], v29, s[4:7], s49 offen sc1
    buffer_load_dwordx4 v[108:111], v30, s[4:7], s49 offen sc1
    s_add_u32 s49, s49, 1024
    s_add_u32 m0, s47, 6144
    s_nop 0
    buffer_load_dwordx4 v26, s[20:23], s48 offen lds
    s_add_u32 m0, s47, 7168
    s_add_u32 s48, s48, 32768
    buffer_load_dwordx4 v26, s[20:23], s48 offen lds
    s_add_u32 s48, s48, 32768
    buffer_load_dwordx4 v[112:115], v3, s[4:7], s49 offen sc1
    buffer_load_dwordx4 v[116:119], v29, s[4:7], s49 offen sc1
    buffer_load_dwordx4 v[120:123], v30, s[4:7], s49 offen sc1
    s_add_u32 s49, s49, 1024
    s_add_u32 m0, s47, 8192
    s_nop 0
    buffer_load_dwordx4 v26, s[20:23], s48 offen lds
    s_add_u32 m0, s47, 9216
    s_add_u32 s48, s48, 32768
    buffer_load_dwordx4 v26, s[20:23], s48 offen lds
    s_add_u32 s48, s48, 32768
    buffer_load_dwordx4 v[124:127], v3, s[4:7], s49 offen sc1
    buffer_load_dwordx4 v[128:131], v29, s[4:7], s49 offen sc1
    buffer_load_dwordx4 v[132:135], v30, s[4:7], s49 offen sc1
    s_add_u32 s49, s49, 1024
    s_add_u32 m0, s47, 10240
    s_nop 0
    buffer_load_dwordx4 v26, s[20:23], s48 offen lds
    s_add_u32 m0, s47, 11264
    s_add_u32 s48, s48, 32768
    buffer_load_dwordx4 v26, s[20:23], s48 offen lds
    s_add_u32 s48, s48, 32768
    buffer_load_dwordx4 v[136:139], v3, s[4:7], s49 offen sc1
    buffer_load_dwordx4 v[140:143], v29, s[4:7], s49 offen sc1
    buffer_load_dwordx4 v[144:147], v30, s[4:7], s49 offen sc1
    s_add_u32 s49, s49, 1024
    s_waitcnt vmcnt(25)
    ds_read_b64_tr_b16 v[52:53], v27 offset:0
    ds_read_b64_tr_b16 v[54:55], v27 offset:1024
    ds_read_b64_tr_b16 v[56:57], v28 offset:0
    ds_read_b64_tr_b16 v[58:59], v28 offset:1024
    s_waitcnt vmcnt(20)
    ds_read_b64_tr_b16 v[64:65], v27 offset:2048
    ds_read_b64_tr_b16 v[66:67], v27 offset:3072
    ds_read_b64_tr_b16 v[68:69], v28 offset:2048
    ds_read_b64_tr_b16 v[70:71], v28 offset:3072
    s_waitcnt lgkmcnt(4)
    v_mfma_f32_32x32x16_bf16 v[156:171], v[76:79], v[52:55], 0
    v_mfma_f32_32x32x16_bf16 v[172:187], v[80:83], v[52:55], 0
    v_mfma_f32_32x32x16_bf16 v[188:203], v[84:87], v[52:55], 0
    v_mfma_f32_32x32x16_bf16 v[204:219], v[76:79], v[56:59], 0
    v_mfma_f32_32x32x16_bf16 v[220:235], v[80:83], v[56:59], 0
    v_mfma_f32_32x32x16_bf16 v[236:251], v[84:87], v[56:59], 0
    s_add_u32 m0, s47, 0
    s_nop 0
    buffer_load_dwordx4 v26, s[20:23], s48 offen lds
    s_add_u32 m0, s47, 1024
    s_add_u32 s48, s48, 32768
    buffer_load_dwordx4 v26, s[20:23], s48 offen lds
    s_add_u32 s48, s48, 32768
    buffer_load_dwordx4 v[76:79], v3, s[4:7], s49 offen sc1
    buffer_load_dwordx4 v[80:83], v29, s[4:7], s49 offen sc1
    buffer_load_dwordx4 v[84:87], v30, s[4:7], s49 offen sc1
    s_add_u32 s49, s49, 1024
    s_waitcnt vmcnt(20)
    ds_read_b64_tr_b16 v[52:53], v27 offset:4096
    ds_read_b64_tr_b16 v[54:55], v27 offset:5120
    ds_read_b64_tr_b16 v[56:57], v28 offset:4096
    ds_read_b64_tr_b16 v[58:59], v28 offset:5120
    s_waitcnt lgkmcnt(4)
    v_mfma_f32_32x32x16_bf16 v[156:171], v[88:91], v[64:67], v[156:171]
    v_mfma_f32_32x32x16_bf16 v[172:187], v[92:95], v[64:67], v[172:187]
    v_mfma_f32_32x32x16_bf16 v[188:203], v[96:99], v[64:67], v[188:203]
    v_mfma_f32_32x32x16_bf16 v[204:219], v[88:91], v[68:71], v[204:219]
    v_mfma_f32_32x32x16_bf16 v[220:235], v[92:95], v[68:71], v[220:235]
    v_mfma_f32_32x32x16_bf16 v[236:251], v[96:99], v[68:71], v[236:251]
    s_add_u32 m0, s47, 2048
    s_nop 0
    buffer_load_dwordx4 v26, s[20:23], s48 offen lds
    s_add_u32 m0, s47, 3072
    s_add_u32 s48, s48, 32768
    buffer_load_dwordx4 v26, s[20:23], s48 offen lds
    s_add_u32 s48, s48, 32768
    buffer_load_dwordx4 v[88:91], v3, s[4:7], s49 offen sc1
    buffer_load_dwordx4 v[92:95], v29, s[4:7], s49 offen sc1
    buffer_load_dwordx4 v[96:99], v30, s[4:7], s49 offen sc1
    s_add_u32 s49, s49, 1024
    s_waitcnt vmcnt(20)
    ds_read_b64_tr_b16 v[64:65], v27 offset:6144
    ds_read_b64_tr_b16 v[66:67], v27 offset:7168
    ds_read_b64_tr_b16 v[68:69], v28 offset:6144
    ds_read_b64_tr_b16 v[70:71], v28 offset:7168
    s_waitcnt lgkmcnt(4)
    v_mfma_f32_32x32x16_bf16 v[156:171], v[100:103], v[52:55], v[156:171]
    v_mfma_f32_32x32x16_bf16 v[172:187], v[104:107], v[52:55], v[172:187]
    v_mfma_f32_32x32x16_bf16 v[188:203], v[108:111], v[52:55], v[188:203]
    v_mfma_f32_32x32x16_bf16 v[204:219], v[100:103], v[56:59], v[204:219]
    v_mfma_f32_32x32x16_bf16 v[220:235], v[104:107], v[56:59], v[220:235]
    v_mfma_f32_32x32x16_bf16 v[236:251], v[108:111], v[56:59], v[236:251]
    s_add_u32 m0, s47, 4096
    s_nop 0
    buffer_load_dwordx4 v26, s[20:23], s48 offen lds
    s_add_u32 m0, s47, 5120
    s_add_u32 s48, s48, 32768
    buffer_load_dwordx4 v26, s[20:23], s48 offen lds
    s_add_u32 s48, s48, 32768
    buffer_load_dwordx4 v[100:103], v3, s[4:7], s49 offen sc1
    buffer_load_dwordx4 v[104:107], v29, s[4:7], s49 offen sc1
    buffer_load_dwordx4 v[108:111], v30, s[4:7], s49 offen sc1
    s_add_u32 s49, s49, 1024
    s_waitcnt vmcnt(20)
    ds_read_b64_tr_b16 v[52:53], v27 offset:8192
    ds_read_b64_tr_b16 v[54:55], v27 offset:9216
    ds_read_b64_tr_b16 v[56:57], v28 offset:8192
    ds_read_b64_tr_b16 v[58:59], v28 offset:9216
    s_waitcnt lgkmcnt(4)
    v_mfma_f32_32x32x16_bf16 v[156:171], v[112:115], v[64:67], v[156:171]
    v_mfma_f32_32x32x16_bf16 v[172:187], v[116:119], v[64:67], v[172:187]
    v_mfma_f32_32x32x16_bf16 v[188:203], v[120:123], v[64:67], v[188:203]
    v_mfma_f32_32x32x16_bf16 v[204:219], v[112:115], v[68:71], v[204:219]
    v_mfma_f32_32x32x16_bf16 v[220:235], v[116:119], v[68:71], v[220:235]
    v_mfma_f32_32x32x16_bf16 v[236:251], v[120:123], v[68:71], v[236:251]
    s_add_u32 m0, s47, 6144
    s_nop 0
    buffer_load_dwordx4 v26, s[20:23], s48 offen lds
    s_add_u32 m0, s47, 7168
    s_add_u32 s48, s48, 32768
    buffer_load_dwordx4 v26, s[20:23], s48 offen lds
    s_add_u32 s48, s48, 32768
    buffer_load_dwordx4 v[112:115], v3, s[4:7], s49 offen sc1
    buffer_load_dwordx4 v[116:119], v29, s[4:7], s49 offen sc1
    buffer_load_dwordx4 v[120:123], v30, s[4:7], s49 offen sc1
    s_add_u32 s49, s49, 1024
    s_waitcnt vmcnt(20)
    ds_read_b64_tr_b16 v[64:65], v27 offset:10240
    ds_read_b64_tr_b16 v[66:67], v27 offset:11264
    ds_read_b64_tr_b16 v[68:69], v28 offset:10240
    ds_read_b64_tr_b16 v[70:71], v28 offset:11264
    s_waitcnt lgkmcnt(4)
    v_mfma_f32_32x32x16_bf16 v[156:171], v[124:127], v[52:55], v[156:171]
    v_mfma_f32_32x32x16_bf16 v[172:187], v[128:131], v[52:55], v[172:187]
    v_mfma_f32_32x32x16_bf16 v[188:203], v[132:135], v[52:55], v[188:203]
    v_mfma_f32_32x32x16_bf16 v[204:219], v[124:127], v[56:59], v[204:219]
    v_mfma_f32_32x32x16_bf16 v[220:235], v[128:131], v[56:59], v[220:235]
    v_mfma_f32_32x32x16_bf16 v[236:251], v[132:135], v[56:59], v[236:251]
    s_add_u32 m0, s47, 8192
    s_nop 0
    buffer_load_dwordx4 v26, s[20:23], s48 offen lds
    s_add_u32 m0, s47, 9216
    s_add_u32 s48, s48, 32768
    buffer_load_dwordx4 v26, s[20:23], s48 offen lds
    s_add_u32 s48, s48, 32768
    buffer_load_dwordx4 v[124:127], v3, s[4:7], s49 offen sc1
    buffer_load_dwordx4 v[128:131], v29, s[4:7], s49 offen sc1
    buffer_load_dwordx4 v[132:135], v30, s[4:7], s49 offen sc1
    s_add_u32 s49, s49, 1024
    s_waitcnt vmcnt(20)
    ds_read_b64_tr_b16 v[52:53], v27 offset:0
    ds_read_b64_tr_b16 v[54:55], v27 offset:1024
    ds_read_b64_tr_b16 v[56:57], v28 offset:0
    ds_read_b64_tr_b16 v[58:59], v28 offset:1024
    s_waitcnt lgkmcnt(4)
    v_mfma_f32_32x32x16_bf16 v[156:171], v[136:139], v[64:67], v[156:171]
    v_mfma_f32_32x32x16_bf16 v[172:187], v[140:143], v[64:67], v[172:187]
    v_mfma_f32_32x32x16_bf16 v[188:203], v[144:147], v[64:67], v[188:203]
    v_mfma_f32_32x32x16_bf16 v[204:219], v[136:139], v[68:71], v[204:219]
    v_mfma_f32_32x32x16_bf16 v[220:235], v[140:143], v[68:71], v[220:235]
    v_mfma_f32_32x32x16_bf16 v[236:251], v[144:147], v[68:71], v[236:251]
    s_add_u32 m0, s47, 10240
    s_nop 0
    buffer_load_dwordx4 v26, s[20:23], s48 offen lds
    s_add_u32 m0, s47, 11264
    s_add_u32 s48, s48, 32768
    buffer_load_dwordx4 v26, s[20:23], s48 offen lds
    s_add_u32 s48, s48, 32768
    buffer_load_dwordx4 v[136:139], v3, s[4:7], s49 offen sc1
    buffer_load_dwordx4 v[140:143], v29, s[4:7], s49 offen sc1
    buffer_load_dwordx4 v[144:147], v30, s[4:7], s49 offen sc1
    s_add_u32 s49, s49, 1024
    s_mov_b32 s50, 2
L_m2_loop:
    s_waitcnt vmcnt(20)
    ds_read_b64_tr_b16 v[64:65], v27 offset:2048
    ds_read_b64_tr_b16 v[66:67], v27 offset:3072
    ds_read_b64_tr_b16 v[68:69], v28 offset:2048
    ds_read_b64_tr_b16 v[70:71], v28 offset:3072
    s_waitcnt lgkmcnt(4)
    v_mfma_f32_32x32x16_bf16 v[156:171], v[76:79], v[52:55], v[156:171]
    v_mfma_f32_32x32x16_bf16 v[172:187], v[80:83], v[52:55], v[172:187]
    v_mfma_f32_32x32x16_bf16 v[188:203], v[84:87], v[52:55], v[188:203]
    v_mfma_f32_32x32x16_bf16 v[204:219], v[76:79], v[56:59], v[204:219]
    v_mfma_f32_32x32x16_bf16 v[220:235], v[80:83], v[56:59], v[220:235]
    v_mfma_f32_32x32x16_bf16 v[236:251], v[84:87], v[56:59], v[236:251]
    s_add_u32 m0, s47, 0
    s_nop 0
    buffer_load_dwordx4 v26, s[20:23], s48 offen lds
    s_add_u32 m0, s47, 1024
    s_add_u32 s48, s48, 32768
    buffer_load_dwordx4 v26, s[20:23], s48 offen lds
    s_add_u32 s48, s48, 32768
    buffer_load_dwordx4 v[76:79], v3, s[4:7], s49 offen sc1
    buffer_load_dwordx4 v[80:83], v29, s[4:7], s49 offen sc1
    buffer_load_dwordx4 v[84:87], v30, s[4:7], s49 offen sc1
    s_add_u32 s49, s49, 1024
    s_waitcnt vmcnt(20)
    ds_read_b64_tr_b16 v[52:53], v27 offset:4096
    ds_read_b64_tr_b16 v[54:55], v27 offset:5120
    ds_read_b64_tr_b16 v[56:57], v28 offset:4096
    ds_read_b64_tr_b16 v[58:59], v28 offset:5120
    s_waitcnt lgkmcnt(4)
    v_mfma_f32_32x32x16_bf16 v[156:171], v[88:91], v[64:67], v[156:171]
    v_mfma_f32_32x32x16_bf16 v[172:187], v[92:95], v[64:67], v[172:187]
    v_mfma_f32_32x32x16_bf16 v[188:203], v[96:99], v[64:67], v[188:203]
    v_mfma_f32_32x32x16_bf16 v[204:219], v[88:91], v[68:71], v[204:219]
    v_mfma_f32_32x32x16_bf16 v[220:235], v[92:95], v[68:71], v[220:235]
    v_mfma_f32_32x32x16_bf16 v[236:251], v[96:99], v[68:71], v[236:251]
    s_add_u32 m0, s47, 2048
    s_nop 0
    buffer_load_dwordx4 v26, s[20:23], s48 offen lds
    s_add_u32 m0, s47, 3072
    s_add_u32 s48, s48, 32768
    buffer_load_dwordx4 v26, s[20:23], s48 offen lds
    s_add_u32 s48, s48, 32768
    buffer_load_dwordx4 v[88:91], v3, s[4:7], s49 offen sc1
    buffer_load_dwordx4 v[92:95], v29, s[4:7], s49 offen sc1
    buffer_load_dwordx4 v[96:99], v30, s[4:7], s49 offen sc1
    s_add_u32 s49, s49, 1024
    s_waitcnt vmcnt(20)
    ds_read_b64_tr_b16 v[64:65], v27 offset:6144
    ds_read_b64_tr_b16 v[66:67], v27 offset:7168
    ds_read_b64_tr_b16 v[68:69], v28 offset:6144
    ds_read_b64_tr_b16 v[70:71], v28 offset:7168
    s_waitcnt lgkmcnt(4)
    v_mfma_f32_32x32x16_bf16 v[156:171], v[100:103], v[52:55], v[156:171]
    v_mfma_f32_32x32x16_bf16 v[172:187], v[104:107], v[52:55], v[172:187]
    v_mfma_f32_32x32x16_bf16 v[188:203], v[108:111], v[52:55], v[188:203]
    v_mfma_f32_32x32x16_bf16 v[204:219], v[100:103], v[56:59], v[204:219]
    v_mfma_f32_32x32x16_bf16 v[220:235], v[104:107], v[56:59], v[220:235]
    v_mfma_f32_32x32x16_bf16 v[236:251], v[108:111], v[56:59], v[236:251]
    s_add_u32 m0, s47, 4096
    s_nop 0
    buffer_load_dwordx4 v26, s[20:23], s48 offen lds
    s_add_u32 m0, s47, 5120
    s_add_u32 s48, s48, 32768
    buffer_load_dwordx4 v26, s[20:23], s48 offen lds
    s_add_u32 s48, s48, 32768
    buffer_load_dwordx4 v[100:103], v3, s[4:7], s49 offen sc1
    buffer_load_dwordx4 v[104:107], v29, s[4:7], s49 offen sc1
    buffer_load_dwordx4 v[108:111], v30, s[4:7], s49 offen sc1
    s_add_u32 s49, s49, 1024
    s_waitcnt vmcnt(20)
    ds_read_b64_tr_b16 v[52:53], v27 offset:8192
    ds_read_b64_tr_b16 v[54:55], v27 offset:9216
    ds_read_b64_tr_b16 v[56:57], v28 offset:8192
    ds_read_b64_tr_b16 v[58:59], v28 offset:9216
    s_waitcnt lgkmcnt(4)
    v_mfma_f32_32x32x16_bf16 v[156:171], v[112:115], v[64:67], v[156:171]
    v_mfma_f32_32x32x16_bf16 v[172:187], v[116:119], v[64:67], v[172:187]
    v_mfma_f32_32x32x16_bf16 v[188:203], v[120:123], v[64:67], v[188:203]
    v_mfma_f32_32x32x16_bf16 v[204:219], v[112:115], v[68:71], v[204:219]
    v_mfma_f32_32x32x16_bf16 v[220:235], v[116:119], v[68:71], v[220:235]
    v_mfma_f32_32x32x16_bf16 v[236:251], v[120:123], v[68:71], v[236:251]
    s_add_u32 m0, s47, 6144
    s_nop 0
    buffer_load_dwordx4 v26, s[20:23], s48 offen lds
    s_add_u32 m0, s47, 7168
    s_add_u32 s48, s48, 32768
    buffer_load_dwordx4 v26, s[20:23], s48 offen lds
    s_add_u32 s48, s48, 32768
    buffer_load_dwordx4 v[112:115], v3, s[4:7], s49 offen sc1
    buffer_load_dwordx4 v[116:119], v29, s[4:7], s49 offen sc1
    buffer_load_dwordx4 v[120:123], v30, s[4:7], s49 offen sc1
    s_add_u32 s49, s49, 1024
    s_waitcnt vmcnt(20)
    ds_read_b64_tr_b16 v[64:65], v27 offset:10240
    ds_read_b64_tr_b16 v[66:67], v27 offset:11264
    ds_read_b64_tr_b16 v[68:69], v28 offset:10240
    ds_read_b64_tr_b16 v[70:71], v28 offset:11264
    s_waitcnt lgkmcnt(4)
    v_mfma_f32_32x32x16_bf16 v[156:171], v[124:127], v[52:55], v[156:171]
    v_mfma_f32_32x32x16_bf16 v[172:187], v[128:131], v[52:55], v[172:187]
    v_mfma_f32_32x32x16_bf16 v[188:203], v[132:135], v[52:55], v[188:203]
    v_mfma_f32_32x32x16_bf16 v[204:219], v[124:127], v[56:59], v[204:219]
    v_mfma_f32_32x32x16_bf16 v[220:235], v[128:131], v[56:59], v[220:235]
    v_mfma_f32_32x32x16_bf16 v[236:251], v[132:135], v[56:59], v[236:251]
    s_add_u32 m0, s47, 8192
    s_nop 0
    buffer_load_dwordx4 v26, s[20:23], s48 offen lds
    s_add_u32 m0, s47, 9216
    s_add_u32 s48, s48, 32768
    buffer_load_dwordx4 v26, s[20:23], s48 offen lds
    s_add_u32 s48, s48, 32768
    buffer_load_dwordx4 v[124:127], v3, s[4:7], s49 offen sc1
    buffer_load_dwordx4 v[128:131], v29, s[4:7], s49 offen sc1
    buffer_load_dwordx4 v[132:135], v30, s[4:7], s49 offen sc1
    s_add_u32 s49, s49, 1024
    s_waitcnt vmcnt(20)
    ds_read_b64_tr_b16 v[52:53], v27 offset:0
    ds_read_b64_tr_b16 v[54:55], v27 offset:1024
    ds_read_b64_tr_b16 v[56:57], v28 offset:0
    ds_read_b64_tr_b16 v[58:59], v28 offset:1024
    s_waitcnt lgkmcnt(4)
    v_mfma_f32_32x32x16_bf16 v[156:171], v[136:139], v[64:67], v[156:171]
    v_mfma_f32_32x32x16_bf16 v[172:187], v[140:143], v[64:67], v[172:187]
    v_mfma_f32_32x32x16_bf16 v[188:203], v[144:147], v[64:67], v[188:203]
    v_mfma_f32_32x32x16_bf16 v[204:219], v[136:139], v[68:71], v[204:219]
    v_mfma_f32_32x32x16_bf16 v[220:235], v[140:143], v[68:71], v[220:235]
    v_mfma_f32_32x32x16_bf16 v[236:251], v[144:147], v[68:71], v[236:251]
    s_add_u32 m0, s47, 10240
    s_nop 0
    buffer_load_dwordx4 v26, s[20:23], s48 offen lds
    s_add_u32 m0, s47, 11264
    s_add_u32 s48, s48, 32768
    buffer_load_dwordx4 v26, s[20:23], s48 offen lds
    s_add_u32 s48, s48, 32768
    buffer_load_dwordx4 v[136:139], v3, s[4:7], s49 offen sc1
    buffer_load_dwordx4 v[140:143], v29, s[4:7], s49 offen sc1
    buffer_load_dwordx4 v[144:147], v30, s[4:7], s49 offen sc1
    s_add_u32 s49, s49, 1024
    s_sub_u32 s50, s50, 1
    s_cmp_lg_u32 s50, 0
    s_cbranch_scc1 L_m2_loop
    s_waitcnt vmcnt(20)
    ds_read_b64_tr_b16 v[64:65], v27 offset:2048
    ds_read_b64_tr_b16 v[66:67], v27 offset:3072
    ds_read_b64_tr_b16 v[68:69], v28 offset:2048
    ds_read_b64_tr_b16 v[70:71], v28 offset:3072
    s_waitcnt lgkmcnt(4)
    v_mfma_f32_32x32x16_bf16 v[156:171], v[76:79], v[52:55], v[156:171]
    v_mfma_f32_32x32x16_bf16 v[172:187], v[80:83], v[52:55], v[172:187]
    v_mfma_f32_32x32x16_bf16 v[188:203], v[84:87], v[52:55], v[188:203]
    v_mfma_f32_32x32x16_bf16 v[204:219], v[76:79], v[56:59], v[204:219]
    v_mfma_f32_32x32x16_bf16 v[220:235], v[80:83], v[56:59], v[220:235]
    v_mfma_f32_32x32x16_bf16 v[236:251], v[84:87], v[56:59], v[236:251]
    s_waitcnt vmcnt(15)
    ds_read_b64_tr_b16 v[52:53], v27 offset:4096
    ds_read_b64_tr_b16 v[54:55], v27 offset:5120
    ds_read_b64_tr_b16 v[56:57], v28 offset:4096
    ds_read_b64_tr_b16 v[58:59], v28 offset:5120
    s_waitcnt lgkmcnt(4)
    v_mfma_f32_32x32x16_bf16 v[156:171], v[88:91], v[64:67], v[156:171]
    v_mfma_f32_32x32x16_bf16 v[172:187], v[92:95], v[64:67], v[172:187]
    v_mfma_f32_32x32x16_bf16 v[188:203], v[96:99], v[64:67], v[188:203]
    v_mfma_f32_32x32x16_bf16 v[204:219], v[88:91], v[68:71], v[204:219]
    v_mfma_f32_32x32x16_bf16 v[220:235], v[92:95], v[68:71], v[220:235]
    v_mfma_f32_32x32x16_bf16 v[236:251], v[96:99], v[68:71], v[236:251]
    s_waitcnt vmcnt(10)
    ds_read_b64_tr_b16 v[64:65], v27 offset:6144
    ds_read_b64_tr_b16 v[66:67], v27 offset:7168
    ds_read_b64_tr_b16 v[68:69], v28 offset:6144
    ds_read_b64_tr_b16 v[70:71], v28 offset:7168
    s_waitcnt lgkmcnt(4)
    v_mfma_f32_32x32x16_bf16 v[156:171], v[100:103], v[52:55], v[156:171]
    v_mfma_f32_32x32x16_bf16 v[172:187], v[104:107], v[52:55], v[172:187]
    v_mfma_f32_32x32x16_bf16 v[188:203], v[108:111], v[52:55], v[188:203]
    v_mfma_f32_32x32x16_bf16 v[204:219], v[100:103], v[56:59], v[204:219]
    v_mfma_f32_32x32x16_bf16 v[220:235], v[104:107], v[56:59], v[220:235]
    v_mfma_f32_32x32x16_bf16 v[236:251], v[108:111], v[56:59], v[236:251]
    s_waitcnt vmcnt(5)
    ds_read_b64_tr_b16 v[52:53], v27 offset:8192
    ds_read_b64_tr_b16 v[54:55], v27 offset:9216
    ds_read_b64_tr_b16 v[56:57], v28 offset:8192
    ds_read_b64_tr_b16 v[58:59], v28 offset:9216
    s_waitcnt lgkmcnt(4)
    v_mfma_f32_32x32x16_bf16 v[156:171], v[112:115], v[64:67], v[156:171]
    v_mfma_f32_32x32x16_bf16 v[172:187], v[116:119], v[64:67], v[172:187]
    v_mfma_f32_32x32x16_bf16 v[188:203], v[120:123], v[64:67], v[188:203]
    v_mfma_f32_32x32x16_bf16 v[204:219], v[112:115], v[68:71], v[204:219]
    v_mfma_f32_32x32x16_bf16 v[220:235], v[116:119], v[68:71], v[220:235]
    v_mfma_f32_32x32x16_bf16 v[236:251], v[120:123], v[68:71], v[236:251]
    s_waitcnt vmcnt(0)
    ds_read_b64_tr_b16 v[64:65], v27 offset:10240
    ds_read_b64_tr_b16 v[66:67], v27 offset:11264
    ds_read_b64_tr_b16 v[68:69], v28 offset:10240
    ds_read_b64_tr_b16 v[70:71], v28 offset:11264
    s_waitcnt lgkmcnt(4)
    v_mfma_f32_32x32x16_bf16 v[156:171], v[124:127], v[52:55], v[156:171]
    v_mfma_f32_32x32x16_bf16 v[172:187], v[128:131], v[52:55], v[172:187]
    v_mfma_f32_32x32x16_bf16 v[188:203], v[132:135], v[52:55], v[188:203]
    v_mfma_f32_32x32x16_bf16 v[204:219], v[124:127], v[56:59], v[204:219]
    v_mfma_f32_32x32x16_bf16 v[220:235], v[128:131], v[56:59], v[220:235]
    v_mfma_f32_32x32x16_bf16 v[236:251], v[132:135], v[56:59], v[236:251]
    s_waitcnt lgkmcnt(0)
    v_mfma_f32_32x32x16_bf16 v[156:171], v[136:139], v[64:67], v[156:171]
    v_mfma_f32_32x32x16_bf16 v[172:187], v[140:143], v[64:67], v[172:187]
    v_mfma_f32_32x32x16_bf16 v[188:203], v[144:147], v[64:67], v[188:203]
    v_mfma_f32_32x32x16_bf16 v[204:219], v[136:139], v[68:71], v[204:219]
    v_mfma_f32_32x32x16_bf16 v[220:235], v[140:143], v[68:71], v[220:235]
    v_mfma_f32_32x32x16_bf16 v[236:251], v[144:147], v[68:71], v[236:251]
    s_setprio 0
    s_lshl_b32 s32, s8, 12
    s_lshl_b32 s56, s46, 10
    s_add_u32 s32, s32, s56
    s_add_u32 s32, s32, 8585216
    v_and_b32 v4, 7, v0
    v_lshlrev_b32 v4, 7, v4
    s_mul_i32 s54, s9, 52
    s_lshr_b32 s54, s54, 8
    s_mul_i32 s54, s54, 5
    s_sub_u32 s54, s9, s54
    s_mov_b32 s51, s54
    s_add_u32 s54, s54, 1
    s_cmp_eq_u32 s54, 5
    s_cselect_b32 s54, 0, s54
    s_mov_b32 s52, s54
    s_add_u32 s54, s54, 1
    s_cmp_eq_u32 s54, 5
    s_cselect_b32 s54, 0, s54
    s_mov_b32 s53, s54
    s_add_u32 s54, s54, 1
    s_cmp_eq_u32 s54, 5
    s_cselect_b32 s54, 0, s54
    s_mov_b32 s50, s54
    s_add_u32 s54, s54, 1
    s_cmp_eq_u32 s54, 5
    s_cselect_b32 s54, 0, s54
    s_mov_b32 s48, s54
    s_add_u32 s54, s54, 1
    s_cmp_eq_u32 s54, 5
    s_cselect_b32 s54, 0, s54
    s_add_u32 m0, s47, 0
    s_mul_i32 s55, s51, 40960
    s_add_u32 s55, s55, s59
    buffer_load_dwordx4 v46, s[24:27], s55 offen lds
    s_add_u32 m0, s47, 1024
    s_nop 0
    buffer_load_dwordx4 v47, s[24:27], s55 offen lds
    s_add_u32 m0, s47, 2048
    s_nop 0
    buffer_load_dwordx4 v48, s[24:27], s55 offen lds
    s_add_u32 m0, s47, 3072
    s_nop 0
    buffer_load_dwordx4 v49, s[24:27], s55 offen lds
    s_add_u32 m0, s47, 4096
    s_nop 0
    buffer_load_dwordx4 v50, s[24:27], s55 offen lds
    s_add_u32 m0, s47, 5120
    s_mul_i32 s55, s52, 40960
    s_add_u32 s55, s55, s59
    buffer_load_dwordx4 v46, s[24:27], s55 offen lds
    s_add_u32 m0, s47, 6144
    s_nop 0
    buffer_load_dwordx4 v47, s[24:27], s55 offen lds
    s_add_u32 m0, s47, 7168
    s_nop 0
    buffer_load_dwordx4 v48, s[24:27], s55 offen lds
    s_add_u32 m0, s47, 8192
    s_nop 0
    buffer_load_dwordx4 v49, s[24:27], s55 offen lds
    s_add_u32 m0, s47, 9216
    s_nop 0
    buffer_load_dwordx4 v50, s[24:27], s55 offen lds
    s_add_u32 m0, s47, 10240
    s_mul_i32 s55, s53, 40960
    s_add_u32 s55, s55, s59
    buffer_load_dwordx4 v46, s[24:27], s55 offen lds
    s_add_u32 m0, s47, 11264
    s_nop 0
    buffer_load_dwordx4 v47, s[24:27], s55 offen lds
    s_add_u32 m0, s47, 12288
    s_nop 0
    buffer_load_dwordx4 v48, s[24:27], s55 offen lds
    s_add_u32 m0, s47, 13312
    s_nop 0
    buffer_load_dwordx4 v49, s[24:27], s55 offen lds
    s_add_u32 m0, s47, 14336
    s_nop 0
    buffer_load_dwordx4 v50, s[24:27], s55 offen lds
    v_lshlrev_b32 v15, 16, v15
    v_lshlrev_b32 v16, 16, v36
    v_and_b32 v17, 0xffff0000, v36
    v_lshlrev_b32 v18, 16, v37
    v_and_b32 v19, 0xffff0000, v37
    v_lshlrev_b32 v20, 16, v38
    v_and_b32 v21, 0xffff0000, v38
    v_lshlrev_b32 v22, 16, v39
    v_and_b32 v23, 0xffff0000, v39
    v_lshlrev_b32 v24, 16, v40
    v_and_b32 v25, 0xffff0000, v40
    v_lshlrev_b32 v26, 16, v41
    v_and_b32 v27, 0xffff0000, v41
    v_lshlrev_b32 v28, 16, v42
    v_and_b32 v29, 0xffff0000, v42
    v_lshlrev_b32 v30, 16, v43
    v_and_b32 v31, 0xffff0000, v43
    v_lshlrev_b32 v32, 16, v44
    v_and_b32 v33, 0xffff0000, v44
    v_lshlrev_b32 v34, 16, v45
    v_and_b32 v35, 0xffff0000, v45
    v_mov_b32 v8, v15
    v_pk_add_f32 v[16:17], v[16:17], v[8:9] op_sel_hi:[1,0]
    v_pk_add_f32 v[18:19], v[18:19], v[8:9] op_sel_hi:[1,0]
    v_pk_add_f32 v[20:21], v[20:21], v[8:9] op_sel_hi:[1,0]
    v_pk_add_f32 v[22:23], v[22:23], v[8:9] op_sel_hi:[1,0]
    v_pk_add_f32 v[24:25], v[24:25], v[8:9] op_sel_hi:[1,0]
    v_pk_add_f32 v[26:27], v[26:27], v[8:9] op_sel_hi:[1,0]
    v_pk_add_f32 v[28:29], v[28:29], v[8:9] op_sel_hi:[1,0]
    v_pk_add_f32 v[30:31], v[30:31], v[8:9] op_sel_hi:[1,0]
    v_pk_add_f32 v[32:33], v[32:33], v[8:9] op_sel_hi:[1,0]
    v_pk_add_f32 v[34:35], v[34:35], v[8:9] op_sel_hi:[1,0]
    s_mul_i32 s49, s8, 81920
    s_mul_i32 s54, s46, 10240
    s_add_u32 s49, s49, s54
    s_add_u32 s49, s49, 5767168
    s_mov_b32 s57, 0
L_pf18:
    buffer_load_dword v5, v4, s[4:7], s32 offen sc1
    s_add_u32 s57, s57, 1
    s_waitcnt vmcnt(0)
    v_cmp_ne_u32 vcc, s11, v5
    s_cmp_ge_u32 s57, 65536
    s_cbranch_scc1 L_pf18_ok
    s_nop 1
    s_cbranch_vccz L_pf18_ok
    s_sleep 1
    s_branch L_pf18
L_pf18_ok:
L_o_ready:
    s_lshl_b32 s54, s51, 11
    s_add_u32 s54, s54, s49
    buffer_load_dwordx4 v[76:79], v3, s[4:7], s54 offen offset:0 sc1
    buffer_load_dwordx4 v[80:83], v14, s[4:7], s54 offen offset:0 sc1
    buffer_load_dwordx4 v[84:87], v3, s[4:7], s54 offen offset:1024 sc1
    buffer_load_dwordx4 v[88:91], v14, s[4:7], s54 offen offset:1024 sc1
    s_lshl_b32 s54, s52, 11
    s_add_u32 s54, s54, s49
    buffer_load_dwordx4 v[92:95], v3, s[4:7], s54 offen offset:0 sc1
    buffer_load_dwordx4 v[96:99], v14, s[4:7], s54 offen offset:0 sc1
    buffer_load_dwordx4 v[100:103], v3, s[4:7], s54 offen offset:1024 sc1
    buffer_load_dwordx4 v[104:107], v14, s[4:7], s54 offen offset:1024 sc1
    s_lshl_b32 s54, s53, 11
    s_add_u32 s54, s54, s49
    buffer_load_dwordx4 v[108:111], v3, s[4:7], s54 offen offset:0 sc1
    buffer_load_dwordx4 v[112:115], v14, s[4:7], s54 offen offset:0 sc1
    buffer_load_dwordx4 v[116:119], v3, s[4:7], s54 offen offset:1024 sc1
    buffer_load_dwordx4 v[120:123], v14, s[4:7], s54 offen offset:1024 sc1
    s_lshl_b32 s54, s50, 11
    s_add_u32 s54, s54, s49
    buffer_load_dwordx4 v[124:127], v3, s[4:7], s54 offen offset:0 sc1
    buffer_load_dwordx4 v[128:131], v14, s[4:7], s54 offen offset:0 sc1
    buffer_load_dwordx4 v[132:135], v3, s[4:7], s54 offen offset:1024 sc1
    buffer_load_dwordx4 v[136:139], v14, s[4:7], s54 offen offset:1024 sc1
    s_lshl_b32 s54, s48, 11
    s_add_u32 s54, s54, s49
    buffer_load_dwordx4 v[140:143], v3, s[4:7], s54 offen offset:0 sc1
    buffer_load_dwordx4 v[144:147], v14, s[4:7], s54 offen offset:0 sc1
    buffer_load_dwordx4 v[148:151], v3, s[4:7], s54 offen offset:1024 sc1
    buffer_load_dwordx4 v[152:155], v14, s[4:7], s54 offen offset:1024 sc1
    s_waitcnt vmcnt(16)
    ds_read_b64_tr_b16 v[52:53], v51 offset:0
    ds_read_b64_tr_b16 v[54:55], v51 offset:640
    ds_read_b64_tr_b16 v[56:57], v51 offset:64
    ds_read_b64_tr_b16 v[58:59], v51 offset:704
    ds_read_b64_tr_b16 v[60:61], v51 offset:128
    ds_read_b64_tr_b16 v[62:63], v51 offset:768
    ds_read_b64_tr_b16 v[64:65], v51 offset:2560
    ds_read_b64_tr_b16 v[66:67], v51 offset:3200
    ds_read_b64_tr_b16 v[68:69], v51 offset:2624
    ds_read_b64_tr_b16 v[70:71], v51 offset:3264
    ds_read_b64_tr_b16 v[72:73], v51 offset:2688
    ds_read_b64_tr_b16 v[74:75], v51 offset:3328
    s_waitcnt lgkmcnt(6)
    v_mfma_f32_32x32x16_bf16 v[156:171], v[52:55], v[76:79], v[156:171]
    v_mfma_f32_32x32x16_bf16 v[204:219], v[52:55], v[80:83], v[204:219]
    v_mfma_f32_32x32x16_bf16 v[172:187], v[56:59], v[76:79], v[172:187]
    v_mfma_f32_32x32x16_bf16 v[220:235], v[56:59], v[80:83], v[220:235]
    v_mfma_f32_32x32x16_bf16 v[188:203], v[60:63], v[76:79], v[188:203]
    v_mfma_f32_32x32x16_bf16 v[236:251], v[60:63], v[80:83], v[236:251]
    s_waitcnt lgkmcnt(0)
    v_mfma_f32_32x32x16_bf16 v[156:171], v[64:67], v[84:87], v[156:171]
    v_mfma_f32_32x32x16_bf16 v[204:219], v[64:67], v[88:91], v[204:219]
    v_mfma_f32_32x32x16_bf16 v[172:187], v[68:71], v[84:87], v[172:187]
    v_mfma_f32_32x32x16_bf16 v[220:235], v[68:71], v[88:91], v[220:235]
    v_mfma_f32_32x32x16_bf16 v[188:203], v[72:75], v[84:87], v[188:203]
    v_mfma_f32_32x32x16_bf16 v[236:251], v[72:75], v[88:91], v[236:251]
    s_add_u32 m0, s47, 0
    s_mul_i32 s55, s50, 40960
    s_add_u32 s55, s55, s59
    buffer_load_dwordx4 v46, s[24:27], s55 offen lds
    s_add_u32 m0, s47, 1024
    s_nop 0
    buffer_load_dwordx4 v47, s[24:27], s55 offen lds
    s_add_u32 m0, s47, 2048
    s_nop 0
    buffer_load_dwordx4 v48, s[24:27], s55 offen lds
    s_add_u32 m0, s47, 3072
    s_nop 0
    buffer_load_dwordx4 v49, s[24:27], s55 offen lds
    s_add_u32 m0, s47, 4096
    s_nop 0
    buffer_load_dwordx4 v50, s[24:27], s55 offen lds
    s_waitcnt vmcnt(17)
    ds_read_b64_tr_b16 v[52:53], v51 offset:5120
    ds_read_b64_tr_b16 v[54:55], v51 offset:5760
    ds_read_b64_tr_b16 v[56:57], v51 offset:5184
    ds_read_b64_tr_b16 v[58:59], v51 offset:5824
    ds_read_b64_tr_b16 v[60:61], v51 offset:5248
    ds_read_b64_tr_b16 v[62:63], v51 offset:5888
    ds_read_b64_tr_b16 v[64:65], v51 offset:7680
    ds_read_b64_tr_b16 v[66:67], v51 offset:8320
    ds_read_b64_tr_b16 v[68:69], v51 offset:7744
    ds_read_b64_tr_b16 v[70:71], v51 offset:8384
    ds_read_b64_tr_b16 v[72:73], v51 offset:7808
    ds_read_b64_tr_b16 v[74:75], v51 offset:8448
    s_waitcnt lgkmcnt(6)
    v_mfma_f32_32x32x16_bf16 v[156:171], v[52:55], v[92:95], v[156:171]
    v_mfma_f32_32x32x16_bf16 v[204:219], v[52:55], v[96:99], v[204:219]
    v_mfma_f32_32x32x16_bf16 v[172:187], v[56:59], v[92:95], v[172:187]
    v_mfma_f32_32x32x16_bf16 v[220:235], v[56:59], v[96:99], v[220:235]
    v_mfma_f32_32x32x16_bf16 v[188:203], v[60:63], v[92:95], v[188:203]
    v_mfma_f32_32x32x16_bf16 v[236:251], v[60:63], v[96:99], v[236:251]
    s_waitcnt lgkmcnt(0)
    v_mfma_f32_32x32x16_bf16 v[156:171], v[64:67], v[100:103], v[156:171]
    v_mfma_f32_32x32x16_bf16 v[204:219], v[64:67], v[104:107], v[204:219]
    v_mfma_f32_32x32x16_bf16 v[172:187], v[68:71], v[100:103], v[172:187]
    v_mfma_f32_32x32x16_bf16 v[220:235], v[68:71], v[104:107], v[220:235]
    v_mfma_f32_32x32x16_bf16 v[188:203], v[72:75], v[100:103], v[188:203]
    v_mfma_f32_32x32x16_bf16 v[236:251], v[72:75], v[104:107], v[236:251]
    s_add_u32 m0, s47, 5120
    s_mul_i32 s55, s48, 40960
    s_add_u32 s55, s55, s59
    buffer_load_dwordx4 v46, s[24:27], s55 offen lds
    s_add_u32 m0, s47, 6144
    s_nop 0
    buffer_load_dwordx4 v47, s[24:27], s55 offen lds
    s_add_u32 m0, s47, 7168
    s_nop 0
    buffer_load_dwordx4 v48, s[24:27], s55 offen lds
    s_add_u32 m0, s47, 8192
    s_nop 0
    buffer_load_dwordx4 v49, s[24:27], s55 offen lds
    s_add_u32 m0, s47, 9216
    s_nop 0
    buffer_load_dwordx4 v50, s[24:27], s55 offen lds
    s_waitcnt vmcnt(18)
    ds_read_b64_tr_b16 v[52:53], v51 offset:10240
    ds_read_b64_tr_b16 v[54:55], v51 offset:10880
    ds_read_b64_tr_b16 v[56:57], v51 offset:10304
    ds_read_b64_tr_b16 v[58:59], v51 offset:10944
    ds_read_b64_tr_b16 v[60:61], v51 offset:10368
    ds_read_b64_tr_b16 v[62:63], v51 offset:11008
    ds_read_b64_tr_b16 v[64:65], v51 offset:12800
    ds_read_b64_tr_b16 v[66:67], v51 offset:13440
    ds_read_b64_tr_b16 v[68:69], v51 offset:12864
    ds_read_b64_tr_b16 v[70:71], v51 offset:13504
    ds_read_b64_tr_b16 v[72:73], v51 offset:12928
    ds_read_b64_tr_b16 v[74:75], v51 offset:13568
    s_waitcnt lgkmcnt(6)
    v_mfma_f32_32x32x16_bf16 v[156:171], v[52:55], v[108:111], v[156:171]
    v_mfma_f32_32x32x16_bf16 v[204:219], v[52:55], v[112:115], v[204:219]
    v_mfma_f32_32x32x16_bf16 v[172:187], v[56:59], v[108:111], v[172:187]
    v_mfma_f32_32x32x16_bf16 v[220:235], v[56:59], v[112:115], v[220:235]
    v_mfma_f32_32x32x16_bf16 v[188:203], v[60:63], v[108:111], v[188:203]
    v_mfma_f32_32x32x16_bf16 v[236:251], v[60:63], v[112:115], v[236:251]
    s_waitcnt lgkmcnt(0)
    v_mfma_f32_32x32x16_bf16 v[156:171], v[64:67], v[116:119], v[156:171]
    v_mfma_f32_32x32x16_bf16 v[204:219], v[64:67], v[120:123], v[204:219]
    v_mfma_f32_32x32x16_bf16 v[172:187], v[68:71], v[116:119], v[172:187]
    v_mfma_f32_32x32x16_bf16 v[220:235], v[68:71], v[120:123], v[220:235]
    v_mfma_f32_32x32x16_bf16 v[188:203], v[72:75], v[116:119], v[188:203]
    v_mfma_f32_32x32x16_bf16 v[236:251], v[72:75], v[120:123], v[236:251]
    s_waitcnt vmcnt(5)
    ds_read_b64_tr_b16 v[52:53], v51 offset:0
    ds_read_b64_tr_b16 v[54:55], v51 offset:640
    ds_read_b64_tr_b16 v[56:57], v51 offset:64
    ds_read_b64_tr_b16 v[58:59], v51 offset:704
    ds_read_b64_tr_b16 v[60:61], v51 offset:128
    ds_read_b64_tr_b16 v[62:63], v51 offset:768
    ds_read_b64_tr_b16 v[64:65], v51 offset:2560
    ds_read_b64_tr_b16 v[66:67], v51 offset:3200
    ds_read_b64_tr_b16 v[68:69], v51 offset:2624
    ds_read_b64_tr_b16 v[70:71], v51 offset:3264
    ds_read_b64_tr_b16 v[72:73], v51 offset:2688
    ds_read_b64_tr_b16 v[74:75], v51 offset:3328
    s_waitcnt lgkmcnt(6)
    v_mfma_f32_32x32x16_bf16 v[156:171], v[52:55], v[124:127], v[156:171]
    v_mfma_f32_32x32x16_bf16 v[204:219], v[52:55], v[128:131], v[204:219]
    v_mfma_f32_32x32x16_bf16 v[172:187], v[56:59], v[124:127], v[172:187]
    v_mfma_f32_32x32x16_bf16 v[220:235], v[56:59], v[128:131], v[220:235]
    v_mfma_f32_32x32x16_bf16 v[188:203], v[60:63], v[124:127], v[188:203]
    v_mfma_f32_32x32x16_bf16 v[236:251], v[60:63], v[128:131], v[236:251]
    s_waitcnt lgkmcnt(0)
    v_mfma_f32_32x32x16_bf16 v[156:171], v[64:67], v[132:135], v[156:171]
    v_mfma_f32_32x32x16_bf16 v[204:219], v[64:67], v[136:139], v[204:219]
    v_mfma_f32_32x32x16_bf16 v[172:187], v[68:71], v[132:135], v[172:187]
    v_mfma_f32_32x32x16_bf16 v[220:235], v[68:71], v[136:139], v[220:235]
    v_mfma_f32_32x32x16_bf16 v[188:203], v[72:75], v[132:135], v[188:203]
    v_mfma_f32_32x32x16_bf16 v[236:251], v[72:75], v[136:139], v[236:251]
    s_waitcnt vmcnt(0)
    ds_read_b64_tr_b16 v[52:53], v51 offset:5120
    ds_read_b64_tr_b16 v[54:55], v51 offset:5760
    ds_read_b64_tr_b16 v[56:57], v51 offset:5184
    ds_read_b64_tr_b16 v[58:59], v51 offset:5824
    ds_read_b64_tr_b16 v[60:61], v51 offset:5248
    ds_read_b64_tr_b16 v[62:63], v51 offset:5888
    ds_read_b64_tr_b16 v[64:65], v51 offset:7680
    ds_read_b64_tr_b16 v[66:67], v51 offset:8320
    ds_read_b64_tr_b16 v[68:69], v51 offset:7744
    ds_read_b64_tr_b16 v[70:71], v51 offset:8384
    ds_read_b64_tr_b16 v[72:73], v51 offset:7808
    ds_read_b64_tr_b16 v[74:75], v51 offset:8448
    s_waitcnt lgkmcnt(6)
    v_mfma_f32_32x32x16_bf16 v[156:171], v[52:55], v[140:143], v[156:171]
    v_mfma_f32_32x32x16_bf16 v[204:219], v[52:55], v[144:147], v[204:219]
    v_mfma_f32_32x32x16_bf16 v[172:187], v[56:59], v[140:143], v[172:187]
    v_mfma_f32_32x32x16_bf16 v[220:235], v[56:59], v[144:147], v[220:235]
    v_mfma_f32_32x32x16_bf16 v[188:203], v[60:63], v[140:143], v[188:203]
    v_mfma_f32_32x32x16_bf16 v[236:251], v[60:63], v[144:147], v[236:251]
    s_waitcnt lgkmcnt(0)
    v_mfma_f32_32x32x16_bf16 v[156:171], v[64:67], v[148:151], v[156:171]
    v_mfma_f32_32x32x16_bf16 v[204:219], v[64:67], v[152:155], v[204:219]
    v_mfma_f32_32x32x16_bf16 v[172:187], v[68:71], v[148:151], v[172:187]
    v_mfma_f32_32x32x16_bf16 v[220:235], v[68:71], v[152:155], v[220:235]
    v_mfma_f32_32x32x16_bf16 v[188:203], v[72:75], v[148:151], v[188:203]
    v_mfma_f32_32x32x16_bf16 v[236:251], v[72:75], v[152:155], v[236:251]
    s_nop 11
    s_cmp_eq_u32 s46, 0
    s_cbranch_scc1 L_fin_w0
    s_sub_u32 s55, 3, s46
    s_and_b32 s55, s55, 3
    s_mul_i32 s55, s55, 5120
    v_add_u32 v5, s55, v12
    ds_write_b128 v5, v[156:159] offset:0
    ds_write_b128 v5, v[160:163] offset:1024
    ds_write_b128 v5, v[164:167] offset:2048
    ds_write_b128 v5, v[168:171] offset:3072
    ds_write_b128 v5, v[172:175] offset:4096
L_fin_w0:
    s_cmp_eq_u32 s46, 1
    s_cbranch_scc1 L_fin_w1
    s_sub_u32 s55, 4, s46
    s_and_b32 s55, s55, 3
    s_mul_i32 s55, s55, 5120
    v_add_u32 v5, s55, v12
    ds_write_b128 v5, v[176:179] offset:0
    ds_write_b128 v5, v[180:183] offset:1024
    ds_write_b128 v5, v[184:187] offset:2048
    ds_write_b128 v5, v[188:191] offset:3072
    ds_write_b128 v5, v[192:195] offset:4096
L_fin_w1:
    s_cmp_eq_u32 s46, 2
    s_cbranch_scc1 L_fin_w2
    s_sub_u32 s55, 5, s46
    s_and_b32 s55, s55, 3
    s_mul_i32 s55, s55, 5120
    v_add_u32 v5, s55, v12
    ds_write_b128 v5, v[204:207] offset:0
    ds_write_b128 v5, v[208:211] offset:1024
    ds_write_b128 v5, v[212:215] offset:2048
    ds_write_b128 v5, v[216:219] offset:3072
    ds_write_b128 v5, v[220:223] offset:4096
L_fin_w2:
    s_cmp_eq_u32 s46, 3
    s_cbranch_scc1 L_fin_w3
    s_sub_u32 s55, 6, s46
    s_and_b32 s55, s55, 3
    s_mul_i32 s55, s55, 5120
    v_add_u32 v5, s55, v12
    ds_write_b128 v5, v[224:227] offset:0
    ds_write_b128 v5, v[228:231] offset:1024
    ds_write_b128 v5, v[232:235] offset:2048
    ds_write_b128 v5, v[236:239] offset:3072
    ds_write_b128 v5, v[240:243] offset:4096
L_fin_w3:
    s_waitcnt lgkmcnt(0)
    s_mov_b64 exec, 1
    ds_add_u32 v1, v2 offset:20
    s_mov_b64 exec, -1
    s_cmp_lg_u32 s46, 0
    s_cbranch_scc1 L_fin_mv0
    v_pk_add_f32 v[16:17], v[16:17], v[156:157]
    v_pk_add_f32 v[18:19], v[18:19], v[158:159]
    v_pk_add_f32 v[20:21], v[20:21], v[160:161]
    v_pk_add_f32 v[22:23], v[22:23], v[162:163]
    v_pk_add_f32 v[24:25], v[24:25], v[164:165]
    v_pk_add_f32 v[26:27], v[26:27], v[166:167]
    v_pk_add_f32 v[28:29], v[28:29], v[168:169]
    v_pk_add_f32 v[30:31], v[30:31], v[170:171]
    v_pk_add_f32 v[32:33], v[32:33], v[172:173]
    v_pk_add_f32 v[34:35], v[34:35], v[174:175]
L_fin_mv0:
    s_cmp_lg_u32 s46, 1
    s_cbranch_scc1 L_fin_mv1
    v_pk_add_f32 v[16:17], v[16:17], v[176:177]
    v_pk_add_f32 v[18:19], v[18:19], v[178:179]
    v_pk_add_f32 v[20:21], v[20:21], v[180:181]
    v_pk_add_f32 v[22:23], v[22:23], v[182:183]
    v_pk_add_f32 v[24:25], v[24:25], v[184:185]
    v_pk_add_f32 v[26:27], v[26:27], v[186:187]
    v_pk_add_f32 v[28:29], v[28:29], v[188:189]
    v_pk_add_f32 v[30:31], v[30:31], v[190:191]
    v_pk_add_f32 v[32:33], v[32:33], v[192:193]
    v_pk_add_f32 v[34:35], v[34:35], v[194:195]
L_fin_mv1:
    s_cmp_lg_u32 s46, 2
    s_cbranch_scc1 L_fin_mv2
    v_pk_add_f32 v[16:17], v[16:17], v[204:205]
    v_pk_add_f32 v[18:19], v[18:19], v[206:207]
    v_pk_add_f32 v[20:21], v[20:21], v[208:209]
    v_pk_add_f32 v[22:23], v[22:23], v[210:211]
    v_pk_add_f32 v[24:25], v[24:25], v[212:213]
    v_pk_add_f32 v[26:27], v[26:27], v[214:215]
    v_pk_add_f32 v[28:29], v[28:29], v[216:217]
    v_pk_add_f32 v[30:31], v[30:31], v[218:219]
    v_pk_add_f32 v[32:33], v[32:33], v[220:221]
    v_pk_add_f32 v[34:35], v[34:35], v[222:223]
L_fin_mv2:
    s_cmp_lg_u32 s46, 3
    s_cbranch_scc1 L_fin_mv3
    v_pk_add_f32 v[16:17], v[16:17], v[224:225]
    v_pk_add_f32 v[18:19], v[18:19], v[226:227]
    v_pk_add_f32 v[20:21], v[20:21], v[228:229]
    v_pk_add_f32 v[22:23], v[22:23], v[230:231]
    v_pk_add_f32 v[24:25], v[24:25], v[232:233]
    v_pk_add_f32 v[26:27], v[26:27], v[234:235]
    v_pk_add_f32 v[28:29], v[28:29], v[236:237]
    v_pk_add_f32 v[30:31], v[30:31], v[238:239]
    v_pk_add_f32 v[32:33], v[32:33], v[240:241]
    v_pk_add_f32 v[34:35], v[34:35], v[242:243]
L_fin_mv3:
    s_mov_b32 s57, 0
L_sp19:
    ds_read_b32 v6, v1 offset:20
    s_add_u32 s57, s57, 1
    s_waitcnt lgkmcnt(0)
    v_readfirstlane_b32 s56, v6
    s_cmp_ge_u32 s57, 1048576
    s_cbranch_scc1 L_sp19_ok
    s_cmp_ge_u32 s56, 4
    s_cbranch_scc0 L_sp19
L_sp19_ok:
    s_add_u32 s55, s46, 1
    s_and_b32 s55, s55, 3
    s_mul_i32 s56, s55, 16384
    s_add_u32 s56, s56, 96256
    v_add_u32 v5, s56, v3
    ds_read_b128 v[76:79], v5 offset:0
    ds_read_b128 v[80:83], v5 offset:1024
    ds_read_b128 v[84:87], v5 offset:2048
    ds_read_b128 v[88:91], v5 offset:3072
    ds_read_b128 v[92:95], v5 offset:4096
    s_add_u32 s55, s46, 2
    s_and_b32 s55, s55, 3
    s_mul_i32 s56, s55, 16384
    s_add_u32 s56, s56, 91136
    v_add_u32 v5, s56, v3
    ds_read_b128 v[96:99], v5 offset:0
    ds_read_b128 v[100:103], v5 offset:1024
    ds_read_b128 v[104:107], v5 offset:2048
    ds_read_b128 v[108:111], v5 offset:3072
    ds_read_b128 v[112:115], v5 offset:4096
    s_add_u32 s55, s46, 3
    s_and_b32 s55, s55, 3
    s_mul_i32 s56, s55, 16384
    s_add_u32 s56, s56, 86016
    v_add_u32 v5, s56, v3
    ds_read_b128 v[116:119], v5 offset:0
    ds_read_b128 v[120:123], v5 offset:1024
    ds_read_b128 v[124:127], v5 offset:2048
    ds_read_b128 v[128:131], v5 offset:3072
    ds_read_b128 v[132:135], v5 offset:4096
    s_waitcnt lgkmcnt(10)
    v_pk_add_f32 v[16:17], v[16:17], v[76:77]
    v_pk_add_f32 v[18:19], v[18:19], v[78:79]
    v_pk_add_f32 v[20:21], v[20:21], v[80:81]
    v_pk_add_f32 v[22:23], v[22:23], v[82:83]
    v_pk_add_f32 v[24:25], v[24:25], v[84:85]
    v_pk_add_f32 v[26:27], v[26:27], v[86:87]
    v_pk_add_f32 v[28:29], v[28:29], v[88:89]
    v_pk_add_f32 v[30:31], v[30:31], v[90:91]
    v_pk_add_f32 v[32:33], v[32:33], v[92:93]
    v_pk_add_f32 v[34:35], v[34:35], v[94:95]
    s_waitcnt lgkmcnt(5)
    v_pk_add_f32 v[16:17], v[16:17], v[96:97]
    v_pk_add_f32 v[18:19], v[18:19], v[98:99]
    v_pk_add_f32 v[20:21], v[20:21], v[100:101]
    v_pk_add_f32 v[22:23], v[22:23], v[102:103]
    v_pk_add_f32 v[24:25], v[24:25], v[104:105]
    v_pk_add_f32 v[26:27], v[26:27], v[106:107]
    v_pk_add_f32 v[28:29], v[28:29], v[108:109]
    v_pk_add_f32 v[30:31], v[30:31], v[110:111]
    v_pk_add_f32 v[32:33], v[32:33], v[112:113]
    v_pk_add_f32 v[34:35], v[34:35], v[114:115]
    s_waitcnt lgkmcnt(0)
    v_pk_add_f32 v[16:17], v[16:17], v[116:117]
    v_pk_add_f32 v[18:19], v[18:19], v[118:119]
    v_pk_add_f32 v[20:21], v[20:21], v[120:121]
    v_pk_add_f32 v[22:23], v[22:23], v[122:123]
    v_pk_add_f32 v[24:25], v[24:25], v[124:125]
    v_pk_add_f32 v[26:27], v[26:27], v[126:127]
    v_pk_add_f32 v[28:29], v[28:29], v[128:129]
    v_pk_add_f32 v[30:31], v[30:31], v[130:131]
    v_pk_add_f32 v[32:33], v[32:33], v[132:133]
    v_pk_add_f32 v[34:35], v[34:35], v[134:135]
    v_cvt_pk_bf16_f32 v76, v16, v17
    v_cvt_pk_bf16_f32 v77, v18, v19
    buffer_store_dwordx2 v[76:77], v13, s[28:31], s58 offen offset:0
    v_cvt_pk_bf16_f32 v78, v20, v21
    v_cvt_pk_bf16_f32 v79, v22, v23
    buffer_store_dwordx2 v[78:79], v13, s[28:31], s58 offen offset:16
    v_cvt_pk_bf16_f32 v80, v24, v25
    v_cvt_pk_bf16_f32 v81, v26, v27
    buffer_store_dwordx2 v[80:81], v13, s[28:31], s58 offen offset:32
    v_cvt_pk_bf16_f32 v82, v28, v29
    v_cvt_pk_bf16_f32 v83, v30, v31
    buffer_store_dwordx2 v[82:83], v13, s[28:31], s58 offen offset:48
    v_cvt_pk_bf16_f32 v84, v32, v33
    v_cvt_pk_bf16_f32 v85, v34, v35
    buffer_store_dwordx2 v[84:85], v13, s[28:31], s58 offen offset:64
L_gdone:
L_end:
    s_endpgm
.section .rodata,"a"
.p2align 6
.amdhsa_kernel parallel_sum__grouped_kv_mqa__mixer_token_mlp__prompt_kernel
  .amdhsa_next_free_vgpr 256
  .amdhsa_next_free_sgpr 102
  .amdhsa_accum_offset 256
  .amdhsa_group_segment_fixed_size 0
  .amdhsa_kernarg_size 104
  .amdhsa_user_sgpr_count 2
  .amdhsa_user_sgpr_kernarg_segment_ptr 1
  .amdhsa_system_sgpr_workgroup_id_x 1
  .amdhsa_float_denorm_mode_32 3
.end_amdhsa_kernel
```
